```python
import torch

def _softmax(x, axis=-1):
    return torch.softmax(x, dim=axis)
def _gelu(x):
    return torch.nn.functional.gelu(x, approximate="tanh")
def _silu(x):
    return torch.nn.functional.silu(x)
def _sigmoid(x):
    return torch.sigmoid(x)
def _layernorm(x, axis=-1, eps=1e-5):
    m = x.mean(dim=axis, keepdim=True)
    v = x.var(dim=axis, keepdim=True, unbiased=False)
    return (x - m) / torch.sqrt(v + eps)
def _scatter_add(tgt, idx, src, axis=0):
    return tgt.clone().index_add_(axis, idx, src)
def _segment_sum(src, seg, n):
    out = torch.zeros((n,) + src.shape[1:], dtype=src.dtype)
    return out.index_add_(0, seg, src)
def _pad(x, pw):
    flat = tuple(v for pair in reversed(pw) for v in pair)
    return torch.nn.functional.pad(x, flat)

kernel_name = 'parallel_sum__gqa_block_cached__glu_gated_geglu__decode'

def setup_inputs():

    _w = (lambda a: (lambda t: t.to(torch.bfloat16) if t.is_floating_point() else t)(torch.as_tensor(a)))
    def _A_setup():
        B, Sq, D = 1, 1, 576
        Hq, Hkv, Sk, Dh = 32, 16, 65536, 128
        assert Hq % Hkv == 0, (Hq, Hkv)
        return {
            "x": _w((lambda *s: torch.randn(*s, dtype=torch.bfloat16) * 0.05)(B, Sq, D)),
            "k_cache": _w((lambda *s: torch.randn(*s, dtype=torch.bfloat16) * 1.6)(B, Hkv, Sk, Dh)),
            "v_cache": _w((lambda *s: torch.randn(*s, dtype=torch.bfloat16) * 1.6)(B, Hkv, Sk, Dh)),
            "wq": _w((lambda *s: torch.randn(*s, dtype=torch.bfloat16) * 1.6)(D, Hq * Dh) * (D ** -0.5)),
            "wo": _w((lambda *s: torch.randn(*s, dtype=torch.bfloat16) * 1.6)(Hq * Dh, D) * ((Hq * Dh) ** -0.5)),
        }
    _A_in = _A_setup()

    def _B_setup():
        B, S, Dm, Df = 1, 1, 576, 4608
        return {
            "x": _w((lambda *s: torch.randn(*s, dtype=torch.bfloat16) * 0.05)(B, S, Dm)),
            "w_gate": _w((lambda *s: torch.randn(*s, dtype=torch.bfloat16) * 0.8)(Dm, Df) * (Dm ** -0.5)),
            "w_up": _w((lambda *s: torch.randn(*s, dtype=torch.bfloat16) * 0.8)(Dm, Df) * (Dm ** -0.5)),
            "w_down": _w((lambda *s: torch.randn(*s, dtype=torch.bfloat16) * 0.8)(Df, Dm) * (Df ** -0.5)),
        }
    _B_in = _B_setup()

    return {
        "A_x": _A_in["x"],
        "A_k_cache": _A_in["k_cache"],
        "A_v_cache": _A_in["v_cache"],
        "A_wq": _A_in["wq"],
        "A_wo": _A_in["wo"],
        "B_x": _B_in["x"],
        "B_w_gate": _B_in["w_gate"],
        "B_w_up": _B_in["w_up"],
        "B_w_down": _B_in["w_down"],
    }

def reference(A_x, A_k_cache, A_v_cache, A_wq, A_wo, B_x, B_w_gate, B_w_up, B_w_down):
    def _A_ref(x, k_cache, v_cache, wq, wo):
        B, Sq, D = x.shape
        Hq, Dh = 32, 128
        Hkv = k_cache.shape[1]
        rep = Hq // Hkv
        q = (lambda x, *d: x.permute(*d))((x @ wq).reshape(B, Sq, Hq, Dh), 0, 2, 1, 3)
        k = (lambda x, n, axis: torch.repeat_interleave(x, n, dim=axis))(k_cache, rep, axis=1)
        v = (lambda x, n, axis: torch.repeat_interleave(x, n, dim=axis))(v_cache, rep, axis=1)
        scores = torch.einsum("bhqd,bhkd->bhqk", q, k) * (Dh ** -0.5)
        p = _softmax(scores, axis=-1)
        o = torch.einsum("bhqk,bhkd->bhqd", p, v)
        return (lambda x, *d: x.permute(*d))(o, 0, 2, 1, 3).reshape(B, Sq, Hq * Dh) @ wo

    def _B_ref(x, w_gate, w_up, w_down):
        g = torch.einsum("bsd,df->bsf", x, w_gate)
        u = torch.einsum("bsd,df->bsf", x, w_up)
        h = _gelu(g) * u
        return torch.einsum("bsf,fd->bsd", h, w_down)

    x = A_x
    xn = _layernorm(x, axis=-1)
    return x + _A_ref(xn, A_k_cache, A_v_cache, A_wq, A_wo) + _B_ref(xn, B_w_gate, B_w_up, B_w_down)
```

```asm
; @launch grid=(256,1,1) block=(512,1,1) lds=28224
.amdgcn_target "amdgcn-amd-amdhsa--gfx950"
.text
.globl parallel_sum__gqa_block_cached__glu_gated_geglu__decode_kernel
.p2align 8
.type parallel_sum__gqa_block_cached__glu_gated_geglu__decode_kernel,@function
parallel_sum__gqa_block_cached__glu_gated_geglu__decode_kernel:
s_cmp_ge_u32 s2, 256
s_cbranch_scc1 L_end
s_load_dwordx16 s[8:23], s[0:1], 0
s_load_dwordx8 s[24:31], s[0:1], 64
v_lshrrev_b32 v1, 6, v0
v_and_b32 v0, 63, v0
s_lshr_b32 s4, s2, 4
s_and_b32 s5, s2, 15
v_readfirstlane_b32 s3, v1
s_mov_b32 s88, 0x3fb8aa3b
s_mov_b32 s89, 0x3db504f3
s_mov_b32 s90, 0xffff0000
v_and_b32 v6, 1, v0
v_lshlrev_b32 v6, 4, v6
v_mov_b32 v7, 0xffff
v_lshlrev_b32 v7, v6, v7
v_bfe_u32 v8, v0, 1, 2
v_cmp_eq_u32 vcc, 0, v8
s_nop 1
v_cndmask_b32 v2, 0, v7, vcc
v_cmp_eq_u32 vcc, 1, v8
s_nop 1
v_cndmask_b32 v3, 0, v7, vcc
v_cmp_eq_u32 vcc, 2, v8
s_nop 1
v_cndmask_b32 v4, 0, v7, vcc
v_cmp_eq_u32 vcc, 3, v8
s_nop 1
v_cndmask_b32 v5, 0, v7, vcc
s_lshl_b32 s56, s4, 4
s_add_u32 s56, s56, s5
s_waitcnt lgkmcnt(0)
s_mov_b32 s40, s30
s_mov_b32 s41, s31
s_mov_b32 s42, 0xc0000
s_mov_b32 s43, 0x20000
s_cmp_ge_u32 s3, 4
s_cbranch_scc1 L_stream
v_mov_b32 v125, 0
v_lshlrev_b32 v120, 2, v0
v_lshlrev_b32 v121, 4, v0
v_lshrrev_b32 v124, 3, v0
v_and_b32 v123, 7, v0
v_lshlrev_b32 v123, 4, v123
v_lshrrev_b32 v6, 5, v0
v_lshlrev_b32 v6, 8, v6
v_and_b32 v7, 3, v124
v_lshlrev_b32 v7, 2, v7
v_add3_u32 v122, v6, v7, v123
s_sub_u32 s57, s5, 10
s_and_b32 s6, s57, 3
s_mul_i32 s6, s6, 3
s_add_u32 s6, s6, s4
s_and_b32 s6, s6, 15
s_lshl_b32 s57, s57, 4
s_add_u32 s57, s57, s6
s_cmp_eq_u32 s3, 0
s_cbranch_scc1 L_h0
s_cmp_eq_u32 s3, 1
s_cbranch_scc1 L_h1
s_barrier
s_branch L_hwait
L_h1:
v_mov_b32 v10, -1
v_mov_b32 v11, -1
v_mov_b32 v12, -1
v_mov_b32 v13, -1
s_mul_i32 s6, s56, 1152
s_add_u32 s6, s6, 0x20000
buffer_store_dwordx4 v[10:13], v121, s[40:43], s6 offen sc1
s_mov_b64 exec, 0xf
buffer_store_dword v10, v120, s[40:43], s6 offen offset:1024 sc1
s_mov_b64 exec, -1
s_cmp_lt_u32 s5, 9
s_cbranch_scc0 L_h1_nowo
s_lshl_b32 s6, s5, 4
s_add_u32 s6, s6, s4
s_lshl_b32 s6, s6, 8
s_add_u32 s6, s6, 0x68000
buffer_store_dword v10, v120, s[40:43], s6 offen sc1
L_h1_nowo:
s_cmp_lt_u32 s57, 72
s_cbranch_scc0 L_h1_noffn
s_mul_i32 s6, s57, 2304
s_add_u32 s6, s6, 0x71000
buffer_store_dwordx4 v[10:13], v121, s[40:43], s6 offen sc1
buffer_store_dwordx4 v[10:13], v121, s[40:43], s6 offen offset:1024 sc1
buffer_store_dword v10, v120, s[40:43], s6 offen offset:2048 sc1
L_h1_noffn:
s_cmp_eq_u32 s5, 0
s_cbranch_scc0 L_h1_nocnt
s_mul_i32 s6, s4, 1024
s_add_u32 s6, s6, 0x9a000
v_mov_b32 v14, 0
s_mov_b64 exec, 1
buffer_store_dword v14, v125, s[40:43], s6 offen sc1
buffer_store_dword v14, v125, s[40:43], s6 offen offset:256 sc1
s_mov_b64 exec, -1
L_h1_nocnt:
s_barrier
s_waitcnt vmcnt(0)
v_mov_b32 v10, 1
ds_write_b32 v125, v10 offset:2820
s_branch L_hwait
L_h0:
s_mov_b32 s32, s8
s_mov_b32 s33, s9
s_mov_b32 s34, 0x480
s_mov_b32 s35, 0x20000
s_mov_b32 s36, s14
s_mov_b32 s37, s15
s_mov_b32 s38, 0x480000
s_mov_b32 s39, 0x20000
v_lshlrev_b32 v8, 1, v0
buffer_load_ushort v10, v8, s[32:35], 0 offen offset:0
buffer_load_ushort v11, v8, s[32:35], 0 offen offset:128
buffer_load_ushort v12, v8, s[32:35], 0 offen offset:256
buffer_load_ushort v13, v8, s[32:35], 0 offen offset:384
buffer_load_ushort v14, v8, s[32:35], 0 offen offset:512
buffer_load_ushort v15, v8, s[32:35], 0 offen offset:640
buffer_load_ushort v16, v8, s[32:35], 0 offen offset:768
buffer_load_ushort v17, v8, s[32:35], 0 offen offset:896
buffer_load_ushort v18, v8, s[32:35], 0 offen offset:1024
v_lshlrev_b32 v6, 13, v124
v_add_u32 v6, v6, v123
s_lshr_b32 s58, s5, 2
s_mul_i32 s59, s58, 144
s_lshl_b32 s6, s59, 13
s_lshl_b32 s7, s4, 9
s_add_u32 s6, s6, s7
s_and_b32 s7, s5, 3
s_lshl_b32 s7, s7, 7
s_add_u32 s6, s6, s7
buffer_load_dwordx4 a[0:3], v6, s[36:39], s6 offen nt
s_add_u32 s6, s6, 0x10000
buffer_load_dwordx4 a[4:7], v6, s[36:39], s6 offen nt
s_add_u32 s6, s6, 0x10000
buffer_load_dwordx4 a[8:11], v6, s[36:39], s6 offen nt
s_add_u32 s6, s6, 0x10000
buffer_load_dwordx4 a[12:15], v6, s[36:39], s6 offen nt
s_add_u32 s6, s6, 0x10000
buffer_load_dwordx4 a[16:19], v6, s[36:39], s6 offen nt
s_add_u32 s6, s6, 0x10000
buffer_load_dwordx4 a[20:23], v6, s[36:39], s6 offen nt
s_add_u32 s6, s6, 0x10000
buffer_load_dwordx4 a[24:27], v6, s[36:39], s6 offen nt
s_add_u32 s6, s6, 0x10000
buffer_load_dwordx4 a[28:31], v6, s[36:39], s6 offen nt
s_add_u32 s6, s6, 0x10000
buffer_load_dwordx4 a[32:35], v6, s[36:39], s6 offen nt
s_add_u32 s6, s6, 0x10000
buffer_load_dwordx4 a[36:39], v6, s[36:39], s6 offen nt
s_add_u32 s6, s6, 0x10000
buffer_load_dwordx4 a[40:43], v6, s[36:39], s6 offen nt
s_add_u32 s6, s6, 0x10000
buffer_load_dwordx4 a[44:47], v6, s[36:39], s6 offen nt
s_add_u32 s6, s6, 0x10000
buffer_load_dwordx4 a[48:51], v6, s[36:39], s6 offen nt
s_add_u32 s6, s6, 0x10000
buffer_load_dwordx4 a[52:55], v6, s[36:39], s6 offen nt
s_add_u32 s6, s6, 0x10000
buffer_load_dwordx4 a[56:59], v6, s[36:39], s6 offen nt
s_add_u32 s6, s6, 0x10000
buffer_load_dwordx4 a[60:63], v6, s[36:39], s6 offen nt
s_add_u32 s6, s6, 0x10000
buffer_load_dwordx4 a[64:67], v6, s[36:39], s6 offen nt
s_add_u32 s6, s6, 0x10000
buffer_load_dwordx4 a[68:71], v6, s[36:39], s6 offen nt
ds_write_b32 v125, v125 offset:2816
ds_write_b32 v125, v125 offset:2820
ds_write_b32 v125, v125 offset:2824
ds_write_b32 v125, v125 offset:2828
ds_write_b32 v125, v125 offset:2832
v_mov_b32 v20, -1
v_mov_b32 v21, -1
v_mov_b32 v22, -1
v_mov_b32 v23, -1
ds_write_b128 v121, v[20:23] offset:26624
v_mov_b32 v24, 24
ds_write_b32 v125, v24 offset:27648
s_waitcnt lgkmcnt(0)
s_barrier
s_load_dword s91, s[30:31], 0x99800
s_waitcnt vmcnt(18)
v_lshlrev_b32 v10, 16, v10
v_lshlrev_b32 v11, 16, v11
v_lshlrev_b32 v12, 16, v12
v_lshlrev_b32 v13, 16, v13
v_lshlrev_b32 v14, 16, v14
v_lshlrev_b32 v15, 16, v15
v_lshlrev_b32 v16, 16, v16
v_lshlrev_b32 v17, 16, v17
v_lshlrev_b32 v18, 16, v18
v_add_f32 v19, v10, v11
v_add_f32 v19, v19, v12
v_add_f32 v19, v19, v13
v_add_f32 v19, v19, v14
v_add_f32 v19, v19, v15
v_add_f32 v19, v19, v16
v_add_f32 v19, v19, v17
v_add_f32 v19, v19, v18
s_nop 0
s_nop 0
v_add_f32_dpp v19, v19, v19 row_ror:8 row_mask:0xf bank_mask:0xf
s_nop 1
v_add_f32_dpp v19, v19, v19 row_ror:4 row_mask:0xf bank_mask:0xf
s_nop 1
v_add_f32_dpp v19, v19, v19 row_ror:2 row_mask:0xf bank_mask:0xf
s_nop 1
v_add_f32_dpp v19, v19, v19 row_ror:1 row_mask:0xf bank_mask:0xf
v_mov_b32 v20, v19
s_nop 0
s_nop 0
v_permlane16_swap_b32 v19, v20
v_add_f32 v19, v19, v20
v_mov_b32 v20, v19
s_nop 0
s_nop 0
v_permlane32_swap_b32 v19, v20
v_add_f32 v19, v19, v20
v_mul_f32 v19, 0x3ae38e39, v19
v_cvt_pk_bf16_f32 v21, v19, v19
v_and_b32 v21, s90, v21
v_sub_f32 v22, v10, v19
v_mul_f32 v23, v22, v22
v_sub_f32 v22, v11, v19
v_fmac_f32 v23, v22, v22
v_sub_f32 v22, v12, v19
v_fmac_f32 v23, v22, v22
v_sub_f32 v22, v13, v19
v_fmac_f32 v23, v22, v22
v_sub_f32 v22, v14, v19
v_fmac_f32 v23, v22, v22
v_sub_f32 v22, v15, v19
v_fmac_f32 v23, v22, v22
v_sub_f32 v22, v16, v19
v_fmac_f32 v23, v22, v22
v_sub_f32 v22, v17, v19
v_fmac_f32 v23, v22, v22
v_sub_f32 v22, v18, v19
v_fmac_f32 v23, v22, v22
s_nop 1
v_add_f32_dpp v23, v23, v23 row_ror:8 row_mask:0xf bank_mask:0xf
s_nop 1
v_add_f32_dpp v23, v23, v23 row_ror:4 row_mask:0xf bank_mask:0xf
s_nop 1
v_add_f32_dpp v23, v23, v23 row_ror:2 row_mask:0xf bank_mask:0xf
s_nop 1
v_add_f32_dpp v23, v23, v23 row_ror:1 row_mask:0xf bank_mask:0xf
v_mov_b32 v20, v23
s_nop 0
s_nop 0
v_permlane16_swap_b32 v23, v20
v_add_f32 v23, v23, v20
v_mov_b32 v20, v23
s_nop 0
s_nop 0
v_permlane32_swap_b32 v23, v20
v_add_f32 v23, v23, v20
v_mul_f32 v23, 0x3ae38e39, v23
v_cvt_pk_bf16_f32 v23, v23, v23
v_and_b32 v23, s90, v23
v_add_f32 v23, 0x3727c5ac, v23
v_cvt_pk_bf16_f32 v23, v23, v23
v_and_b32 v23, s90, v23
v_sqrt_f32 v23, v23
s_nop 0
v_cvt_pk_bf16_f32 v23, v23, v23
v_and_b32 v23, s90, v23
v_rcp_f32 v24, v23
v_sub_f32 v22, v10, v21
v_cvt_pk_bf16_f32 v22, v22, v22
v_and_b32 v22, s90, v22
v_mul_f32 v25, v22, v24
v_fma_f32 v26, -v25, v23, v22
v_fma_f32 v25, v26, v24, v25
v_cvt_pk_bf16_f32 v48, v25, v25
ds_write_b32 v120, v48 offset:0
v_sub_f32 v22, v11, v21
v_cvt_pk_bf16_f32 v22, v22, v22
v_and_b32 v22, s90, v22
v_mul_f32 v25, v22, v24
v_fma_f32 v26, -v25, v23, v22
v_fma_f32 v25, v26, v24, v25
v_cvt_pk_bf16_f32 v49, v25, v25
ds_write_b32 v120, v49 offset:256
v_sub_f32 v22, v12, v21
v_cvt_pk_bf16_f32 v22, v22, v22
v_and_b32 v22, s90, v22
v_mul_f32 v25, v22, v24
v_fma_f32 v26, -v25, v23, v22
v_fma_f32 v25, v26, v24, v25
v_cvt_pk_bf16_f32 v50, v25, v25
ds_write_b32 v120, v50 offset:512
v_sub_f32 v22, v13, v21
v_cvt_pk_bf16_f32 v22, v22, v22
v_and_b32 v22, s90, v22
v_mul_f32 v25, v22, v24
v_fma_f32 v26, -v25, v23, v22
v_fma_f32 v25, v26, v24, v25
v_cvt_pk_bf16_f32 v51, v25, v25
ds_write_b32 v120, v51 offset:768
v_sub_f32 v22, v14, v21
v_cvt_pk_bf16_f32 v22, v22, v22
v_and_b32 v22, s90, v22
v_mul_f32 v25, v22, v24
v_fma_f32 v26, -v25, v23, v22
v_fma_f32 v25, v26, v24, v25
v_cvt_pk_bf16_f32 v52, v25, v25
ds_write_b32 v120, v52 offset:1024
v_sub_f32 v22, v15, v21
v_cvt_pk_bf16_f32 v22, v22, v22
v_and_b32 v22, s90, v22
v_mul_f32 v25, v22, v24
v_fma_f32 v26, -v25, v23, v22
v_fma_f32 v25, v26, v24, v25
v_cvt_pk_bf16_f32 v53, v25, v25
ds_write_b32 v120, v53 offset:1280
v_sub_f32 v22, v16, v21
v_cvt_pk_bf16_f32 v22, v22, v22
v_and_b32 v22, s90, v22
v_mul_f32 v25, v22, v24
v_fma_f32 v26, -v25, v23, v22
v_fma_f32 v25, v26, v24, v25
v_cvt_pk_bf16_f32 v54, v25, v25
ds_write_b32 v120, v54 offset:1536
v_sub_f32 v22, v17, v21
v_cvt_pk_bf16_f32 v22, v22, v22
v_and_b32 v22, s90, v22
v_mul_f32 v25, v22, v24
v_fma_f32 v26, -v25, v23, v22
v_fma_f32 v25, v26, v24, v25
v_cvt_pk_bf16_f32 v55, v25, v25
ds_write_b32 v120, v55 offset:1792
v_sub_f32 v22, v18, v21
v_cvt_pk_bf16_f32 v22, v22, v22
v_and_b32 v22, s90, v22
v_mul_f32 v25, v22, v24
v_fma_f32 v26, -v25, v23, v22
v_fma_f32 v25, v26, v24, v25
v_cvt_pk_bf16_f32 v56, v25, v25
ds_write_b32 v120, v56 offset:2048
s_lshl_b32 s6, s59, 2
v_lshlrev_b32 v7, 2, v124
v_add_u32 v7, s6, v7
ds_read_b32 v64, v7 offset:0
ds_read_b32 v65, v7 offset:32
ds_read_b32 v66, v7 offset:64
ds_read_b32 v67, v7 offset:96
ds_read_b32 v68, v7 offset:128
ds_read_b32 v69, v7 offset:160
ds_read_b32 v70, v7 offset:192
ds_read_b32 v71, v7 offset:224
ds_read_b32 v72, v7 offset:256
ds_read_b32 v73, v7 offset:288
ds_read_b32 v74, v7 offset:320
ds_read_b32 v75, v7 offset:352
ds_read_b32 v76, v7 offset:384
ds_read_b32 v77, v7 offset:416
ds_read_b32 v78, v7 offset:448
ds_read_b32 v79, v7 offset:480
ds_read_b32 v80, v7 offset:512
ds_read_b32 v81, v7 offset:544
v_mov_b32 v20, 0
v_mov_b32 v21, 0
v_mov_b32 v22, 0
v_mov_b32 v23, 0
s_waitcnt lgkmcnt(0)
s_add_u32 s91, s91, 1
v_and_b32 v24, v64, v2
v_and_b32 v25, v64, v3
v_and_b32 v26, v64, v4
v_and_b32 v27, v64, v5
s_waitcnt vmcnt(17)
s_nop 0
v_mfma_f32_16x16x32_bf16 v[20:23], a[0:3], v[24:27], v[20:23]
v_and_b32 v28, v65, v2
v_and_b32 v29, v65, v3
v_and_b32 v30, v65, v4
v_and_b32 v31, v65, v5
s_waitcnt vmcnt(16)
s_nop 0
v_mfma_f32_16x16x32_bf16 v[20:23], a[4:7], v[28:31], v[20:23]
v_and_b32 v24, v66, v2
v_and_b32 v25, v66, v3
v_and_b32 v26, v66, v4
v_and_b32 v27, v66, v5
s_waitcnt vmcnt(15)
s_nop 0
v_mfma_f32_16x16x32_bf16 v[20:23], a[8:11], v[24:27], v[20:23]
v_and_b32 v28, v67, v2
v_and_b32 v29, v67, v3
v_and_b32 v30, v67, v4
v_and_b32 v31, v67, v5
s_waitcnt vmcnt(14)
s_nop 0
v_mfma_f32_16x16x32_bf16 v[20:23], a[12:15], v[28:31], v[20:23]
v_and_b32 v24, v68, v2
v_and_b32 v25, v68, v3
v_and_b32 v26, v68, v4
v_and_b32 v27, v68, v5
s_waitcnt vmcnt(13)
s_nop 0
v_mfma_f32_16x16x32_bf16 v[20:23], a[16:19], v[24:27], v[20:23]
v_and_b32 v28, v69, v2
v_and_b32 v29, v69, v3
v_and_b32 v30, v69, v4
v_and_b32 v31, v69, v5
s_waitcnt vmcnt(12)
s_nop 0
v_mfma_f32_16x16x32_bf16 v[20:23], a[20:23], v[28:31], v[20:23]
v_and_b32 v24, v70, v2
v_and_b32 v25, v70, v3
v_and_b32 v26, v70, v4
v_and_b32 v27, v70, v5
s_waitcnt vmcnt(11)
s_nop 0
v_mfma_f32_16x16x32_bf16 v[20:23], a[24:27], v[24:27], v[20:23]
v_and_b32 v28, v71, v2
v_and_b32 v29, v71, v3
v_and_b32 v30, v71, v4
v_and_b32 v31, v71, v5
s_waitcnt vmcnt(10)
s_nop 0
v_mfma_f32_16x16x32_bf16 v[20:23], a[28:31], v[28:31], v[20:23]
v_and_b32 v24, v72, v2
v_and_b32 v25, v72, v3
v_and_b32 v26, v72, v4
v_and_b32 v27, v72, v5
s_waitcnt vmcnt(9)
s_nop 0
v_mfma_f32_16x16x32_bf16 v[20:23], a[32:35], v[24:27], v[20:23]
v_and_b32 v28, v73, v2
v_and_b32 v29, v73, v3
v_and_b32 v30, v73, v4
v_and_b32 v31, v73, v5
s_waitcnt vmcnt(8)
s_nop 0
v_mfma_f32_16x16x32_bf16 v[20:23], a[36:39], v[28:31], v[20:23]
v_and_b32 v24, v74, v2
v_and_b32 v25, v74, v3
v_and_b32 v26, v74, v4
v_and_b32 v27, v74, v5
s_waitcnt vmcnt(7)
s_nop 0
v_mfma_f32_16x16x32_bf16 v[20:23], a[40:43], v[24:27], v[20:23]
v_and_b32 v28, v75, v2
v_and_b32 v29, v75, v3
v_and_b32 v30, v75, v4
v_and_b32 v31, v75, v5
s_waitcnt vmcnt(6)
s_nop 0
v_mfma_f32_16x16x32_bf16 v[20:23], a[44:47], v[28:31], v[20:23]
v_and_b32 v24, v76, v2
v_and_b32 v25, v76, v3
v_and_b32 v26, v76, v4
v_and_b32 v27, v76, v5
s_waitcnt vmcnt(5)
s_nop 0
v_mfma_f32_16x16x32_bf16 v[20:23], a[48:51], v[24:27], v[20:23]
v_and_b32 v28, v77, v2
v_and_b32 v29, v77, v3
v_and_b32 v30, v77, v4
v_and_b32 v31, v77, v5
s_waitcnt vmcnt(4)
s_nop 0
v_mfma_f32_16x16x32_bf16 v[20:23], a[52:55], v[28:31], v[20:23]
v_and_b32 v24, v78, v2
v_and_b32 v25, v78, v3
v_and_b32 v26, v78, v4
v_and_b32 v27, v78, v5
s_waitcnt vmcnt(3)
s_nop 0
v_mfma_f32_16x16x32_bf16 v[20:23], a[56:59], v[24:27], v[20:23]
v_and_b32 v28, v79, v2
v_and_b32 v29, v79, v3
v_and_b32 v30, v79, v4
v_and_b32 v31, v79, v5
s_waitcnt vmcnt(2)
s_nop 0
v_mfma_f32_16x16x32_bf16 v[20:23], a[60:63], v[28:31], v[20:23]
v_and_b32 v24, v80, v2
v_and_b32 v25, v80, v3
v_and_b32 v26, v80, v4
v_and_b32 v27, v80, v5
s_waitcnt vmcnt(1)
s_nop 0
v_mfma_f32_16x16x32_bf16 v[20:23], a[64:67], v[24:27], v[20:23]
v_and_b32 v28, v81, v2
v_and_b32 v29, v81, v3
v_and_b32 v30, v81, v4
v_and_b32 v31, v81, v5
s_waitcnt vmcnt(0)
s_nop 0
v_mfma_f32_16x16x32_bf16 v[20:23], a[68:71], v[28:31], v[20:23]
s_nop 1
s_nop 5
ds_write_b128 v121, v[20:23] offset:8192
ds_read_b32 v24, v122 offset:8192
ds_read_b32 v25, v122 offset:8832
s_waitcnt lgkmcnt(0)
v_add_f32 v24, v24, v25
v_mov_b32 v25, s91
s_mov_b32 s82, 0
L_sp_1:
ds_read_b32 v26, v125 offset:2820
s_waitcnt lgkmcnt(0)
v_readfirstlane_b32 s6, v26
s_nop 0
s_cmp_eq_u32 s6, 1
s_cbranch_scc1 L_spd_2
s_sleep 1
s_add_u32 s82, s82, 1
s_cmp_lt_u32 s82, 0x100000
s_cbranch_scc1 L_sp_1
s_branch L_exit
L_spd_2:
s_lshl_b32 s6, s56, 9
s_add_u32 s6, s6, 0x0
v_lshlrev_b32 v8, 3, v0
buffer_store_dwordx2 v[24:25], v8, s[40:43], s6 offen sc1
s_waitcnt vmcnt(0)
s_lshl_b32 s6, s4, 13
s_add_u32 s6, s6, 0x0
s_add_u32 s7, s6, 4096
v_lshlrev_b32 v8, 5, v0
s_mov_b32 s82, 0
L_h0_gq:
buffer_load_dwordx4 v[64:67], v8, s[40:43], s6 offen offset:0 sc1
buffer_load_dwordx4 v[68:71], v8, s[40:43], s6 offen offset:16 sc1
buffer_load_dwordx4 v[72:75], v8, s[40:43], s6 offen offset:2048 sc1
buffer_load_dwordx4 v[76:79], v8, s[40:43], s6 offen offset:2064 sc1
buffer_load_dwordx4 v[80:83], v8, s[40:43], s7 offen offset:0 sc1
buffer_load_dwordx4 v[84:87], v8, s[40:43], s7 offen offset:16 sc1
buffer_load_dwordx4 v[88:91], v8, s[40:43], s7 offen offset:2048 sc1
buffer_load_dwordx4 v[92:95], v8, s[40:43], s7 offen offset:2064 sc1
s_waitcnt vmcnt(0)
v_min3_u32 v26, v65, v67, v69
v_max3_u32 v27, v65, v67, v69
v_min3_u32 v26, v26, v71, v73
v_max3_u32 v27, v27, v71, v73
v_min3_u32 v26, v26, v75, v77
v_max3_u32 v27, v27, v75, v77
v_min3_u32 v26, v26, v79, v81
v_max3_u32 v27, v27, v79, v81
v_min3_u32 v26, v26, v83, v85
v_max3_u32 v27, v27, v83, v85
v_min3_u32 v26, v26, v87, v89
v_max3_u32 v27, v27, v87, v89
v_min3_u32 v26, v26, v91, v93
v_max3_u32 v27, v27, v91, v93
v_min_u32 v26, v26, v95
v_max_u32 v27, v27, v95
v_cmp_ne_u32 vcc, s91, v26
s_cmp_lg_u64 vcc, 0
s_cbranch_scc1 L_h0_gq_retry
v_cmp_ne_u32 vcc, s91, v27
s_cmp_lg_u64 vcc, 0
s_cbranch_scc1 L_h0_gq_retry
v_add_f32 v64, v64, v72
v_add_f32 v64, v64, v80
v_add_f32 v64, v64, v88
v_add_f32 v66, v66, v74
v_add_f32 v66, v66, v82
v_add_f32 v66, v66, v90
v_add_f32 v68, v68, v76
v_add_f32 v68, v68, v84
v_add_f32 v68, v68, v92
v_add_f32 v70, v70, v78
v_add_f32 v70, v70, v86
v_add_f32 v70, v70, v94
v_cvt_pk_bf16_f32 v64, v64, v66
v_cvt_pk_bf16_f32 v65, v68, v70
v_lshlrev_b32 v8, 3, v0
ds_write_b64 v8, v[64:65] offset:2304
v_mov_b32 v10, 1
s_waitcnt lgkmcnt(0)
ds_write_b32 v125, v10 offset:2816
s_branch L_hjob
L_h0_gq_retry:
s_sleep 1
s_add_u32 s82, s82, 1
s_cmp_lt_u32 s82, 0x100000
s_cbranch_scc1 L_h0_gq
s_branch L_exit
L_hwait:
s_mov_b32 s82, 0
L_sp_3:
ds_read_b32 v26, v125 offset:2816
s_waitcnt lgkmcnt(0)
v_readfirstlane_b32 s6, v26
s_nop 0
s_cmp_eq_u32 s6, 1
s_cbranch_scc1 L_spd_4
s_sleep 1
s_add_u32 s82, s82, 1
s_cmp_lt_u32 s82, 0x100000
s_cbranch_scc1 L_sp_3
s_branch L_exit
L_spd_4:
L_hjob:
s_cmp_lt_u32 s5, 9
s_cbranch_scc1 L_job_wo
s_cmp_eq_u32 s5, 9
s_cbranch_scc1 L_job_fin
s_cmp_eq_u32 s3, 0
s_cbranch_scc1 L_preB1
s_cmp_lt_u32 s57, 72
s_cbranch_scc1 L_job_ffn
L_preB1:
s_cmp_eq_u32 s3, 0
s_cbranch_scc0 L_B1
s_mov_b32 s64, 0x903a9000
s_mov_b32 s65, 0x90ae9074
s_mov_b32 s66, 0x912290e8
s_mov_b32 s67, 0x9196915c
s_mov_b32 s68, 0x920a91d0
s_mov_b32 s69, 0x62786244
s_mov_b32 s70, 0x5ae062ac
s_mov_b32 s71, 0x93465b13
s_mov_b32 s72, 0x903a9000
s_mov_b32 s73, 0x90ae9074
s_mov_b32 s74, 0x912290e8
s_mov_b32 s75, 0x9196915c
s_mov_b32 s76, 0x8a0989d0
s_mov_b32 s77, 0x5a755a42
s_mov_b32 s78, 0x5adb5aa8
s_mov_b32 s79, 0x8b478b0e
s_lshr_b32 s6, s4, 3
s_lshl_b32 s6, s6, 4
s_add_u32 s6, s6, s5
s_lshr_b32 s7, s6, 1
s_mov_b32 m0, s7
s_and_b32 s6, s6, 1
s_lshl_b32 s6, s6, 4
s_movrels_b32 s7, s64
s_lshr_b32 s7, s7, s6
s_and_b32 s62, s7, 0x7ff
s_bfe_u32 s67, s7, 0x5000b
s_add_u32 s67, s67, 40
s_mul_i32 s72, s4, 1024
s_add_u32 s72, s72, 0x9a000
s_mov_b32 s73, 0
s_lshl_b32 s74, s67, 2
s_sub_u32 s74, s74, 0
s_mov_b32 s82, 0
L_disp:
ds_read_b32 v96, v125 offset:27648
s_waitcnt lgkmcnt(0)
v_readfirstlane_b32 s75, v96
s_nop 0
s_sub_u32 s75, s75, s74
s_ashr_i32 s75, s75, 2
s_add_u32 s75, s75, 1
s_sub_u32 s75, s75, s73
s_cmp_gt_i32 s75, 0
s_cbranch_scc1 L_disp_go
s_sleep 2
s_add_u32 s82, s82, 1
s_cmp_lt_u32 s82, 0x100000
s_cbranch_scc1 L_disp
s_branch L_exit
L_disp_go:
s_min_u32 s75, s75, 4
v_mov_b32 v96, s75
s_mov_b64 exec, 1
buffer_atomic_add v96, v125, s[40:43], s72 offen sc0 sc1
s_waitcnt vmcnt(0)
v_readfirstlane_b32 s76, v96
s_lshl_b32 s6, 1, s75
s_sub_u32 s6, s6, 1
s_mov_b32 exec_lo, s6
v_add_u32 v96, s76, v0
v_add_u32 v97, 896, v96
v_lshlrev_b32 v97, 14, v97
v_mov_b32 v98, 0x1000000
v_cmp_gt_u32 vcc, 128, v96
s_nop 1
v_cndmask_b32 v97, v98, v97, vcc
s_lshl_b32 s6, s73, 2
v_add_u32 v98, s6, v120
ds_write_b32 v98, v97 offset:26624
s_mov_b64 exec, -1
s_add_u32 s73, s73, s75
s_add_u32 s76, s76, s75
s_mov_b32 s82, 0
s_cmp_le_u32 s76, 128
s_cbranch_scc1 L_disp
s_mov_b32 s55, 15
s_cmp_eq_u32 s5, 9
s_cbranch_scc0 L_role_get
s_cmp_lt_u32 s4, 9
s_cbranch_scc1 L_role_put
L_role_get:
v_mov_b32 v96, 1
s_mov_b64 exec, 1
buffer_atomic_add v96, v125, s[40:43], s72 offen offset:256 sc0 sc1
s_waitcnt vmcnt(0)
v_readfirstlane_b32 s6, v96
s_mov_b64 exec, -1
s_cmp_lt_u32 s6, 9
s_cselect_b32 s55, s6, 15
L_role_put:
v_mov_b32 v96, s55
ds_write_b32 v125, v96 offset:2836
L_B1:
s_mov_b32 s48, s26
s_mov_b32 s49, s27
s_mov_b32 s50, 0x480
s_mov_b32 s51, 0x20000
v_lshrrev_b32 v88, 4, v0
v_and_b32 v89, 15, v0
v_mul_u32_u24 v94, 1152, v88
v_lshlrev_b32 v90, 4, v89
v_add_u32 v90, v94, v90
v_bfe_u32 v91, v0, 3, 1
v_lshlrev_b32 v91, 3, v91
v_add_u32 v91, v94, v91
v_add_u32 v91, 1024, v91
v_lshlrev_b32 v92, 2, v124
v_lshlrev_b32 v93, 3, v89
v_lshlrev_b32 v94, 1, v88
v_add_u32 v93, v93, v94
s_lshl_b32 s61, s4, 7
s_waitcnt lgkmcnt(0)
s_barrier
ds_read_b32 v95, v125 offset:2836
s_waitcnt lgkmcnt(0)
v_readfirstlane_b32 s55, v95
s_nop 0
s_cmp_lt_u32 s55, 9
s_cbranch_scc1 L_wo_post
s_cmp_eq_u32 s5, 9
s_cbranch_scc0 L_exit
s_cmp_lt_u32 s4, 9
s_cbranch_scc0 L_exit
s_cmp_eq_u32 s3, 0
s_cbranch_scc1 L_fin_post
s_branch L_exit
L_job_wo:
s_branch L_preB1
L_wo_post:
s_barrier
s_mov_b32 s36, s16
s_mov_b32 s37, s17
s_mov_b32 s38, 0x480000
s_mov_b32 s39, 0x20000
v_mul_u32_u24 v6, 1152, v124
v_add_u32 v6, v6, v123
s_lshl_b32 s6, s4, 8
s_lshl_b32 s7, s3, 5
s_add_u32 s6, s6, s7
s_mul_i32 s6, s6, 1152
s_lshl_b32 s7, s55, 7
s_add_u32 s6, s6, s7
s_add_u32 s7, s6, 0
buffer_load_dwordx4 a[0:3], v6, s[36:39], s7 offen nt
s_add_u32 s7, s6, 9216
buffer_load_dwordx4 a[4:7], v6, s[36:39], s7 offen nt
s_add_u32 s7, s6, 18432
buffer_load_dwordx4 a[8:11], v6, s[36:39], s7 offen nt
s_add_u32 s7, s6, 27648
buffer_load_dwordx4 a[12:15], v6, s[36:39], s7 offen nt
s_add_u32 s7, s6, 147456
buffer_load_dwordx4 a[16:19], v6, s[36:39], s7 offen nt
s_add_u32 s7, s6, 156672
buffer_load_dwordx4 a[20:23], v6, s[36:39], s7 offen nt
s_add_u32 s7, s6, 165888
buffer_load_dwordx4 a[24:27], v6, s[36:39], s7 offen nt
s_add_u32 s7, s6, 175104
buffer_load_dwordx4 a[28:31], v6, s[36:39], s7 offen nt
s_mul_i32 s60, s4, 18432
s_add_u32 s60, s60, 0x20000
s_add_u32 s64, s60, 0
s_add_u32 s65, s60, 4608
s_add_u32 s66, s60, 9216
s_add_u32 s67, s60, 13824
s_lshl_b32 s7, s3, 8
s_add_u32 s68, s64, s7
s_add_u32 s69, s65, s7
s_add_u32 s70, s66, s7
s_add_u32 s71, s67, s7
s_mov_b32 s82, 0
s_mov_b64 s[72:73], -1
s_mov_b64 s[74:75], -1
s_mov_b64 s[76:77], -1
s_mov_b64 s[78:79], -1
L_wo_g:
s_cmp_eq_u64 s[72:73], 0
s_cbranch_scc1 L_wo_sk0
s_mov_b64 exec, s[72:73]
buffer_load_dwordx4 v[64:67], v90, s[40:43], s68 offen sc1
buffer_load_dwordx2 v[80:81], v91, s[40:43], s64 offen sc1
L_wo_sk0:
s_cmp_eq_u64 s[74:75], 0
s_cbranch_scc1 L_wo_sk1
s_mov_b64 exec, s[74:75]
buffer_load_dwordx4 v[68:71], v90, s[40:43], s69 offen sc1
buffer_load_dwordx2 v[82:83], v91, s[40:43], s65 offen sc1
L_wo_sk1:
s_cmp_eq_u64 s[76:77], 0
s_cbranch_scc1 L_wo_sk2
s_mov_b64 exec, s[76:77]
buffer_load_dwordx4 v[72:75], v90, s[40:43], s70 offen sc1
buffer_load_dwordx2 v[84:85], v91, s[40:43], s66 offen sc1
L_wo_sk2:
s_cmp_eq_u64 s[78:79], 0
s_cbranch_scc1 L_wo_sk3
s_mov_b64 exec, s[78:79]
buffer_load_dwordx4 v[76:79], v90, s[40:43], s71 offen sc1
buffer_load_dwordx2 v[86:87], v91, s[40:43], s67 offen sc1
L_wo_sk3:
s_mov_b64 exec, -1
s_waitcnt vmcnt(0)
v_max3_u32 v24, v64, v65, v66
v_max3_u32 v25, v68, v69, v70
v_max3_u32 v26, v72, v73, v74
v_max3_u32 v27, v76, v77, v78
v_max3_u32 v24, v24, v67, v80
v_max3_u32 v25, v25, v71, v82
v_max3_u32 v26, v26, v75, v84
v_max3_u32 v27, v27, v79, v86
v_max_u32 v24, v24, v81
v_max_u32 v25, v25, v83
v_max_u32 v26, v26, v85
v_max_u32 v27, v27, v87
v_cmp_eq_u32 s[72:73], -1, v24
v_cmp_eq_u32 s[74:75], -1, v25
v_cmp_eq_u32 s[76:77], -1, v26
v_cmp_eq_u32 s[78:79], -1, v27
s_or_b64 s[6:7], s[72:73], s[74:75]
s_or_b64 vcc, s[76:77], s[78:79]
s_or_b64 vcc, vcc, s[6:7]
s_cbranch_scc1 L_wo_retry
v_max3_f32 v20, v80, v82, v84
v_max_f32 v20, v20, v86
v_mov_b32 v21, v20
s_nop 0
s_nop 0
v_permlane16_swap_b32 v20, v21
v_max_f32 v20, v20, v21
v_mov_b32 v21, v20
s_nop 0
s_nop 0
v_permlane32_swap_b32 v20, v21
v_max_f32 v20, v20, v21
v_sub_f32 v24, v80, v20
v_sub_f32 v25, v82, v20
v_sub_f32 v26, v84, v20
v_sub_f32 v27, v86, v20
v_exp_f32 v24, v24
v_exp_f32 v25, v25
v_exp_f32 v26, v26
v_exp_f32 v27, v27
v_mul_f32 v22, v24, v81
v_fmac_f32 v22, v25, v83
v_fmac_f32 v22, v26, v85
v_fmac_f32 v22, v27, v87
v_mov_b32 v21, v22
s_nop 0
s_nop 0
v_permlane16_swap_b32 v22, v21
v_add_f32 v22, v22, v21
v_mov_b32 v21, v22
s_nop 0
s_nop 0
v_permlane32_swap_b32 v22, v21
v_add_f32 v22, v22, v21
v_mul_f32 v28, v24, v64
v_fmac_f32 v28, v25, v68
v_fmac_f32 v28, v26, v72
v_fmac_f32 v28, v27, v76
v_mul_f32 v29, v24, v65
v_fmac_f32 v29, v25, v69
v_fmac_f32 v29, v26, v73
v_fmac_f32 v29, v27, v77
v_mul_f32 v30, v24, v66
v_fmac_f32 v30, v25, v70
v_fmac_f32 v30, v26, v74
v_fmac_f32 v30, v27, v78
v_mul_f32 v31, v24, v67
v_fmac_f32 v31, v25, v71
v_fmac_f32 v31, v26, v75
v_fmac_f32 v31, v27, v79
v_permlane16_swap_b32 v28, v29
s_nop 0
v_permlane16_swap_b32 v30, v31
v_add_f32 v28, v28, v29
v_add_f32 v30, v30, v31
s_nop 0
s_nop 0
v_permlane32_swap_b32 v28, v30
v_add_f32 v28, v28, v30
v_rcp_f32 v22, v22
s_nop 0
v_mul_f32 v28, v28, v22
v_cvt_pk_bf16_f32 v28, v28, v28
ds_bpermute_b32 v32, v92, v28 offset:0
ds_bpermute_b32 v33, v92, v28 offset:64
ds_bpermute_b32 v34, v92, v28 offset:128
ds_bpermute_b32 v35, v92, v28 offset:192
ds_bpermute_b32 v36, v92, v28 offset:32
ds_bpermute_b32 v37, v92, v28 offset:96
ds_bpermute_b32 v38, v92, v28 offset:160
ds_bpermute_b32 v39, v92, v28 offset:224
v_mov_b32 v20, 0
v_mov_b32 v21, 0
v_mov_b32 v22, 0
v_mov_b32 v23, 0
s_lshl_b32 s6, s3, 11
v_add_u32 v8, s6, v121
s_waitcnt lgkmcnt(0)
v_and_b32 v44, v32, v2
v_and_b32 v45, v32, v3
v_and_b32 v46, v32, v4
v_and_b32 v47, v32, v5
v_and_b32 v48, v33, v2
v_and_b32 v49, v33, v3
v_and_b32 v50, v33, v4
v_and_b32 v51, v33, v5
v_and_b32 v52, v34, v2
v_and_b32 v53, v34, v3
v_and_b32 v54, v34, v4
v_and_b32 v55, v34, v5
v_mfma_f32_16x16x32_bf16 v[20:23], a[0:3], v[44:47], v[20:23]
v_and_b32 v56, v35, v2
v_and_b32 v57, v35, v3
v_and_b32 v58, v35, v4
v_and_b32 v59, v35, v5
v_mfma_f32_16x16x32_bf16 v[20:23], a[4:7], v[48:51], v[20:23]
v_and_b32 v44, v36, v2
v_and_b32 v45, v36, v3
v_and_b32 v46, v36, v4
v_and_b32 v47, v36, v5
v_mfma_f32_16x16x32_bf16 v[20:23], a[8:11], v[52:55], v[20:23]
v_and_b32 v48, v37, v2
v_and_b32 v49, v37, v3
v_and_b32 v50, v37, v4
v_and_b32 v51, v37, v5
v_mfma_f32_16x16x32_bf16 v[20:23], a[12:15], v[56:59], v[20:23]
v_and_b32 v52, v38, v2
v_and_b32 v53, v38, v3
v_and_b32 v54, v38, v4
v_and_b32 v55, v38, v5
v_mfma_f32_16x16x32_bf16 v[20:23], a[16:19], v[44:47], v[20:23]
v_and_b32 v56, v39, v2
v_and_b32 v57, v39, v3
v_and_b32 v58, v39, v4
v_and_b32 v59, v39, v5
v_mfma_f32_16x16x32_bf16 v[20:23], a[20:23], v[48:51], v[20:23]
v_mfma_f32_16x16x32_bf16 v[20:23], a[24:27], v[52:55], v[20:23]
v_mfma_f32_16x16x32_bf16 v[20:23], a[28:31], v[56:59], v[20:23]
s_nop 0
s_nop 4
s_nop 0
s_nop 0
ds_write_b128 v8, v[20:23] offset:8192
s_waitcnt lgkmcnt(0)
s_barrier
s_cmp_eq_u32 s3, 0
s_cbranch_scc0 L_exit
ds_read_b32 v24, v122 offset:8192
ds_read_b32 v25, v122 offset:8832
ds_read_b32 v26, v122 offset:10240
ds_read_b32 v27, v122 offset:10880
ds_read_b32 v28, v122 offset:12288
ds_read_b32 v29, v122 offset:12928
ds_read_b32 v30, v122 offset:14336
ds_read_b32 v31, v122 offset:14976
s_waitcnt lgkmcnt(0)
v_add_f32 v24, v24, v25
v_add_f32 v26, v26, v27
v_add_f32 v28, v28, v29
v_add_f32 v30, v30, v31
v_add_f32 v24, v24, v26
v_add_f32 v28, v28, v30
v_add_f32 v24, v24, v28
s_lshl_b32 s6, s55, 4
s_add_u32 s6, s6, s4
s_lshl_b32 s6, s6, 8
s_add_u32 s6, s6, 0x68000
buffer_store_dword v24, v120, s[40:43], s6 offen sc1
s_branch L_exit
L_wo_retry:
s_add_u32 s82, s82, 1
s_cmp_lt_u32 s82, 0x100000
s_cbranch_scc1 L_wo_g
s_branch L_exit
L_job_fin:
s_cmp_lt_u32 s4, 9
s_cbranch_scc0 L_preB1
s_cmp_eq_u32 s3, 0
s_cbranch_scc0 L_preB1
s_mov_b32 s32, s8
s_mov_b32 s33, s9
s_mov_b32 s34, 0x480
s_mov_b32 s35, 0x20000
v_and_b32 v10, 15, v0
v_lshlrev_b32 v11, 3, v10
v_lshrrev_b32 v12, 4, v0
v_lshlrev_b32 v13, 1, v12
v_add_u32 v11, v11, v13
s_lshl_b32 s61, s4, 7
buffer_load_ushort v15, v11, s[32:35], s61 offen
v_lshlrev_b32 v16, 9, v0
v_add_u32 v16, 4, v16
s_mov_b32 s82, 0
L_fin_flags:
s_mov_b32 s6, 0x0
buffer_load_dword v20, v16, s[40:43], s6 offen sc1
s_mov_b32 s6, 0x8000
buffer_load_dword v21, v16, s[40:43], s6 offen sc1
s_mov_b32 s6, 0x10000
buffer_load_dword v22, v16, s[40:43], s6 offen sc1
s_mov_b32 s6, 0x18000
buffer_load_dword v23, v16, s[40:43], s6 offen sc1
s_waitcnt vmcnt(0)
v_min3_u32 v26, v20, v21, v22
v_max3_u32 v27, v20, v21, v22
v_min_u32 v26, v26, v23
v_max_u32 v27, v27, v23
v_cmp_ne_u32 vcc, s91, v26
s_cmp_lg_u64 vcc, 0
s_cbranch_scc1 L_fin_flags_retry
v_cmp_ne_u32 vcc, s91, v27
s_cmp_lg_u64 vcc, 0
s_cbranch_scc1 L_fin_flags_retry
s_cmp_eq_u32 s4, 0
s_cbranch_scc0 L_fin_flags_ok
v_mov_b32 v20, s91
s_mov_b32 s6, 0x99800
s_mov_b64 exec, 1
buffer_store_dword v20, v125, s[40:43], s6 offen sc1
s_mov_b64 exec, -1
L_fin_flags_ok:
v_mul_u32_u24 v12, 2304, v12
v_lshlrev_b32 v13, 4, v10
v_add_u32 v12, v12, v13
s_lshl_b32 s62, s4, 8
s_add_u32 s62, s62, 0x71000
v_mul_u32_u24 v16, 2304, v0
v_min_u32 v18, 7, v0
v_mul_u32_u24 v18, 2304, v18
s_add_u32 s63, s62, 147456
s_mov_b32 s82, 0
L_fin_p:
buffer_load_dword v20, v16, s[40:43], s62 offen sc1
buffer_load_dword v21, v18, s[40:43], s63 offen sc1
s_waitcnt vmcnt(0)
v_max_u32 v20, v20, v21
v_cmp_eq_u32 vcc, -1, v20
s_cmp_lg_u64 vcc, 0
s_cbranch_scc1 L_fin_p_retry
s_mov_b32 s82, 0
L_fin_f:
s_mov_b32 s6, s62
buffer_load_dwordx4 v[48:51], v12, s[40:43], s6 offen sc1
s_add_u32 s6, s6, 9216
buffer_load_dwordx4 v[52:55], v12, s[40:43], s6 offen sc1
s_add_u32 s6, s6, 9216
buffer_load_dwordx4 v[56:59], v12, s[40:43], s6 offen sc1
s_add_u32 s6, s6, 9216
buffer_load_dwordx4 v[60:63], v12, s[40:43], s6 offen sc1
s_add_u32 s6, s6, 9216
buffer_load_dwordx4 v[64:67], v12, s[40:43], s6 offen sc1
s_add_u32 s6, s6, 9216
buffer_load_dwordx4 v[68:71], v12, s[40:43], s6 offen sc1
s_add_u32 s6, s6, 9216
buffer_load_dwordx4 v[72:75], v12, s[40:43], s6 offen sc1
s_add_u32 s6, s6, 9216
buffer_load_dwordx4 v[76:79], v12, s[40:43], s6 offen sc1
s_add_u32 s6, s6, 9216
buffer_load_dwordx4 v[80:83], v12, s[40:43], s6 offen sc1
s_add_u32 s6, s6, 9216
buffer_load_dwordx4 v[84:87], v12, s[40:43], s6 offen sc1
s_add_u32 s6, s6, 9216
buffer_load_dwordx4 v[88:91], v12, s[40:43], s6 offen sc1
s_add_u32 s6, s6, 9216
buffer_load_dwordx4 v[92:95], v12, s[40:43], s6 offen sc1
s_add_u32 s6, s6, 9216
buffer_load_dwordx4 v[96:99], v12, s[40:43], s6 offen sc1
s_add_u32 s6, s6, 9216
buffer_load_dwordx4 v[100:103], v12, s[40:43], s6 offen sc1
s_add_u32 s6, s6, 9216
buffer_load_dwordx4 v[104:107], v12, s[40:43], s6 offen sc1
s_add_u32 s6, s6, 9216
buffer_load_dwordx4 v[108:111], v12, s[40:43], s6 offen sc1
s_add_u32 s6, s6, 9216
buffer_load_dwordx4 v[112:115], v12, s[40:43], s6 offen sc1
s_add_u32 s6, s6, 9216
buffer_load_dwordx4 v[116:119], v12, s[40:43], s6 offen sc1
s_waitcnt vmcnt(0)
v_max3_u32 v26, v48, v49, v50
v_max3_u32 v26, v26, v51, v52
v_max3_u32 v26, v26, v53, v54
v_max3_u32 v26, v26, v55, v56
v_max3_u32 v26, v26, v57, v58
v_max3_u32 v26, v26, v59, v60
v_max3_u32 v26, v26, v61, v62
v_max3_u32 v26, v26, v63, v64
v_max3_u32 v26, v26, v65, v66
v_max3_u32 v26, v26, v67, v68
v_max3_u32 v26, v26, v69, v70
v_max3_u32 v26, v26, v71, v72
v_max3_u32 v26, v26, v73, v74
v_max3_u32 v26, v26, v75, v76
v_max3_u32 v26, v26, v77, v78
v_max3_u32 v26, v26, v79, v80
v_max3_u32 v26, v26, v81, v82
v_max3_u32 v26, v26, v83, v84
v_max3_u32 v26, v26, v85, v86
v_max3_u32 v26, v26, v87, v88
v_max3_u32 v26, v26, v89, v90
v_max3_u32 v26, v26, v91, v92
v_max3_u32 v26, v26, v93, v94
v_max3_u32 v26, v26, v95, v96
v_max3_u32 v26, v26, v97, v98
v_max3_u32 v26, v26, v99, v100
v_max3_u32 v26, v26, v101, v102
v_max3_u32 v26, v26, v103, v104
v_max3_u32 v26, v26, v105, v106
v_max3_u32 v26, v26, v107, v108
v_max3_u32 v26, v26, v109, v110
v_max3_u32 v26, v26, v111, v112
v_max3_u32 v26, v26, v113, v114
v_max3_u32 v26, v26, v115, v116
v_max3_u32 v26, v26, v117, v118
v_max_u32 v26, v26, v119
v_cmp_eq_u32 vcc, -1, v26
s_cmp_lg_u64 vcc, 0
s_cbranch_scc1 L_fin_f_retry
v_add_f32 v48, v48, v52
v_add_f32 v49, v49, v53
v_add_f32 v50, v50, v54
v_add_f32 v51, v51, v55
v_add_f32 v48, v48, v56
v_add_f32 v49, v49, v57
v_add_f32 v50, v50, v58
v_add_f32 v51, v51, v59
v_add_f32 v48, v48, v60
v_add_f32 v49, v49, v61
v_add_f32 v50, v50, v62
v_add_f32 v51, v51, v63
v_add_f32 v48, v48, v64
v_add_f32 v49, v49, v65
v_add_f32 v50, v50, v66
v_add_f32 v51, v51, v67
v_add_f32 v48, v48, v68
v_add_f32 v49, v49, v69
v_add_f32 v50, v50, v70
v_add_f32 v51, v51, v71
v_add_f32 v48, v48, v72
v_add_f32 v49, v49, v73
v_add_f32 v50, v50, v74
v_add_f32 v51, v51, v75
v_add_f32 v48, v48, v76
v_add_f32 v49, v49, v77
v_add_f32 v50, v50, v78
v_add_f32 v51, v51, v79
v_add_f32 v48, v48, v80
v_add_f32 v49, v49, v81
v_add_f32 v50, v50, v82
v_add_f32 v51, v51, v83
v_add_f32 v48, v48, v84
v_add_f32 v49, v49, v85
v_add_f32 v50, v50, v86
v_add_f32 v51, v51, v87
v_add_f32 v48, v48, v88
v_add_f32 v49, v49, v89
v_add_f32 v50, v50, v90
v_add_f32 v51, v51, v91
v_add_f32 v48, v48, v92
v_add_f32 v49, v49, v93
v_add_f32 v50, v50, v94
v_add_f32 v51, v51, v95
v_add_f32 v48, v48, v96
v_add_f32 v49, v49, v97
v_add_f32 v50, v50, v98
v_add_f32 v51, v51, v99
v_add_f32 v48, v48, v100
v_add_f32 v49, v49, v101
v_add_f32 v50, v50, v102
v_add_f32 v51, v51, v103
v_add_f32 v48, v48, v104
v_add_f32 v49, v49, v105
v_add_f32 v50, v50, v106
v_add_f32 v51, v51, v107
v_add_f32 v48, v48, v108
v_add_f32 v49, v49, v109
v_add_f32 v50, v50, v110
v_add_f32 v51, v51, v111
v_add_f32 v48, v48, v112
v_add_f32 v49, v49, v113
v_add_f32 v50, v50, v114
v_add_f32 v51, v51, v115
v_add_f32 v48, v48, v116
v_add_f32 v49, v49, v117
v_add_f32 v50, v50, v118
v_add_f32 v51, v51, v119
v_permlane16_swap_b32 v48, v49
s_nop 0
v_permlane16_swap_b32 v50, v51
v_add_f32 v48, v48, v49
v_add_f32 v50, v50, v51
s_nop 0
s_nop 0
v_permlane32_swap_b32 v48, v50
v_add_f32 v48, v48, v50
v_cvt_pk_bf16_f32 v17, v48, v48
v_and_b32 v17, s90, v17
v_lshlrev_b32 v15, 16, v15
s_branch L_preB1
L_fin_post:
s_lshl_b32 s62, s4, 12
s_add_u32 s62, s62, 0x68000
s_mov_b32 s82, 0
L_fin_g:
buffer_load_dwordx4 v[48:51], v121, s[40:43], s62 offen offset:0 sc1
buffer_load_dwordx4 v[52:55], v121, s[40:43], s62 offen offset:1024 sc1
buffer_load_dwordx4 v[56:59], v121, s[40:43], s62 offen offset:2048 sc1
buffer_load_dwordx4 v[60:63], v121, s[40:43], s62 offen offset:3072 sc1
s_waitcnt vmcnt(0)
v_max3_u32 v26, v48, v49, v50
v_max3_u32 v26, v26, v51, v52
v_max3_u32 v26, v26, v53, v54
v_max3_u32 v26, v26, v55, v56
v_max3_u32 v26, v26, v57, v58
v_max3_u32 v26, v26, v59, v60
v_max3_u32 v26, v26, v61, v62
v_max_u32 v26, v26, v63
v_cmp_eq_u32 vcc, -1, v26
s_cmp_lg_u64 vcc, 0
s_cbranch_scc1 L_fin_g_retry
v_add_f32 v48, v48, v52
v_add_f32 v56, v56, v60
v_add_f32 v48, v48, v56
v_add_f32 v49, v49, v53
v_add_f32 v57, v57, v61
v_add_f32 v49, v49, v57
v_add_f32 v50, v50, v54
v_add_f32 v58, v58, v62
v_add_f32 v50, v50, v58
v_add_f32 v51, v51, v55
v_add_f32 v59, v59, v63
v_add_f32 v51, v51, v59
v_permlane16_swap_b32 v48, v49
s_nop 0
v_permlane16_swap_b32 v50, v51
v_add_f32 v48, v48, v49
v_add_f32 v50, v50, v51
s_nop 0
s_nop 0
v_permlane32_swap_b32 v48, v50
v_add_f32 v48, v48, v50
v_cvt_pk_bf16_f32 v48, v48, v48
v_and_b32 v48, s90, v48
v_add_f32 v48, v15, v48
v_cvt_pk_bf16_f32 v48, v48, v48
v_and_b32 v48, s90, v48
v_add_f32 v48, v48, v17
v_cvt_pk_bf16_f32 v48, v48, v48
buffer_store_short v48, v93, s[48:51], s61 offen
s_branch L_exit
L_fin_flags_retry:
s_sleep 32
s_add_u32 s82, s82, 1
s_cmp_lt_u32 s82, 0x100000
s_cbranch_scc1 L_fin_flags
s_branch L_exit
L_fin_p_retry:
s_sleep 64
s_add_u32 s82, s82, 1
s_cmp_lt_u32 s82, 0x100000
s_cbranch_scc1 L_fin_p
s_branch L_exit
L_fin_f_retry:
s_sleep 16
s_add_u32 s82, s82, 1
s_cmp_lt_u32 s82, 0x100000
s_cbranch_scc1 L_fin_f
s_branch L_exit
L_fin_g_retry:
s_add_u32 s82, s82, 1
s_cmp_lt_u32 s82, 0x100000
s_cbranch_scc1 L_fin_g
s_branch L_exit
L_job_ffn:
s_mov_b32 s32, s20
s_mov_b32 s33, s21
s_mov_b32 s34, 0x510000
s_mov_b32 s35, 0x20000
s_mov_b32 s36, s22
s_mov_b32 s37, s23
s_mov_b32 s38, 0x510000
s_mov_b32 s39, 0x20000
s_mov_b32 s48, s24
s_mov_b32 s49, s25
s_mov_b32 s50, 0x510000
s_mov_b32 s51, 0x20000
s_sub_u32 s58, s3, 1
v_mul_u32_u24 v6, 9216, v124
v_add_u32 v6, v6, v123
v_mul_u32_u24 v7, 1152, v124
v_add_u32 v7, v7, v123
s_mul_i32 s60, s58, 192
s_lshl_b32 s6, s60, 2
v_lshlrev_b32 v10, 2, v124
v_add_u32 v10, s6, v10
s_mul_i32 s62, s60, 9216
s_lshl_b32 s6, s57, 7
s_add_u32 s62, s62, s6
s_mul_i32 s63, s57, 73728
s_mul_i32 s6, s58, 384
s_add_u32 s63, s63, s6
buffer_load_dwordx4 a[0:3], v6, s[32:35], s62 offen nt
buffer_load_dwordx4 a[4:7], v6, s[36:39], s62 offen nt
s_add_u32 s62, s62, 73728
buffer_load_dwordx4 a[8:11], v6, s[32:35], s62 offen nt
buffer_load_dwordx4 a[12:15], v6, s[36:39], s62 offen nt
s_add_u32 s62, s62, 73728
buffer_load_dwordx4 a[16:19], v6, s[32:35], s62 offen nt
buffer_load_dwordx4 a[20:23], v6, s[36:39], s62 offen nt
s_add_u32 s62, s62, 73728
buffer_load_dwordx4 a[24:27], v6, s[32:35], s62 offen nt
buffer_load_dwordx4 a[28:31], v6, s[36:39], s62 offen nt
s_add_u32 s62, s62, 73728
buffer_load_dwordx4 a[32:35], v6, s[32:35], s62 offen nt
buffer_load_dwordx4 a[36:39], v6, s[36:39], s62 offen nt
s_add_u32 s62, s62, 73728
buffer_load_dwordx4 a[40:43], v6, s[32:35], s62 offen nt
buffer_load_dwordx4 a[44:47], v6, s[36:39], s62 offen nt
s_add_u32 s62, s62, 73728
buffer_load_dwordx4 a[48:51], v6, s[32:35], s62 offen nt
buffer_load_dwordx4 a[52:55], v6, s[36:39], s62 offen nt
s_add_u32 s62, s62, 73728
buffer_load_dwordx4 a[56:59], v6, s[32:35], s62 offen nt
buffer_load_dwordx4 a[60:63], v6, s[36:39], s62 offen nt
s_add_u32 s62, s62, 73728
buffer_load_dwordx4 a[64:67], v6, s[32:35], s62 offen nt
buffer_load_dwordx4 a[68:71], v6, s[36:39], s62 offen nt
s_add_u32 s62, s62, 73728
buffer_load_dwordx4 a[72:75], v6, s[32:35], s62 offen nt
buffer_load_dwordx4 a[76:79], v6, s[36:39], s62 offen nt
s_add_u32 s62, s62, 73728
buffer_load_dwordx4 a[80:83], v6, s[32:35], s62 offen nt
buffer_load_dwordx4 a[84:87], v6, s[36:39], s62 offen nt
s_add_u32 s62, s62, 73728
buffer_load_dwordx4 a[88:91], v6, s[32:35], s62 offen nt
buffer_load_dwordx4 a[92:95], v6, s[36:39], s62 offen nt
s_add_u32 s62, s62, 73728
v_mov_b32 v20, 0
v_mov_b32 v21, 0
v_mov_b32 v22, 0
v_mov_b32 v23, 0
v_mov_b32 v24, 0
v_mov_b32 v25, 0
v_mov_b32 v26, 0
v_mov_b32 v27, 0
v_mov_b32 v28, 0
v_mov_b32 v29, 0
v_mov_b32 v30, 0
v_mov_b32 v31, 0
v_mov_b32 v32, 0
v_mov_b32 v33, 0
v_mov_b32 v34, 0
v_mov_b32 v35, 0
v_mov_b32 v36, 0
v_mov_b32 v37, 0
v_mov_b32 v38, 0
v_mov_b32 v39, 0
ds_read_b32 v48, v10 offset:0
ds_read_b32 v49, v10 offset:32
ds_read_b32 v50, v10 offset:64
ds_read_b32 v51, v10 offset:96
s_waitcnt lgkmcnt(0)
v_and_b32 v44, v48, v2
v_and_b32 v45, v48, v3
v_and_b32 v46, v48, v4
v_and_b32 v47, v48, v5
s_waitcnt vmcnt(23)
s_nop 0
v_mfma_f32_16x16x32_bf16 v[20:23], a[0:3], v[44:47], v[20:23]
buffer_load_dwordx4 a[0:3], v6, s[32:35], s62 offen nt
s_waitcnt vmcnt(23)
v_mfma_f32_16x16x32_bf16 v[24:27], a[4:7], v[44:47], v[24:27]
buffer_load_dwordx4 a[4:7], v6, s[36:39], s62 offen nt
s_add_u32 s62, s62, 73728
v_and_b32 v44, v49, v2
v_and_b32 v45, v49, v3
v_and_b32 v46, v49, v4
v_and_b32 v47, v49, v5
s_waitcnt vmcnt(23)
s_nop 0
v_mfma_f32_16x16x32_bf16 v[20:23], a[8:11], v[44:47], v[20:23]
buffer_load_dwordx4 a[8:11], v6, s[32:35], s62 offen nt
s_waitcnt vmcnt(23)
v_mfma_f32_16x16x32_bf16 v[24:27], a[12:15], v[44:47], v[24:27]
buffer_load_dwordx4 a[12:15], v6, s[36:39], s62 offen nt
s_add_u32 s62, s62, 73728
v_and_b32 v44, v50, v2
v_and_b32 v45, v50, v3
v_and_b32 v46, v50, v4
v_and_b32 v47, v50, v5
s_waitcnt vmcnt(23)
s_nop 0
v_mfma_f32_16x16x32_bf16 v[20:23], a[16:19], v[44:47], v[20:23]
buffer_load_dwordx4 a[16:19], v6, s[32:35], s62 offen nt
s_waitcnt vmcnt(23)
v_mfma_f32_16x16x32_bf16 v[24:27], a[20:23], v[44:47], v[24:27]
buffer_load_dwordx4 a[20:23], v6, s[36:39], s62 offen nt
s_add_u32 s62, s62, 73728
v_and_b32 v44, v51, v2
v_and_b32 v45, v51, v3
v_and_b32 v46, v51, v4
v_and_b32 v47, v51, v5
s_waitcnt vmcnt(23)
s_nop 0
v_mfma_f32_16x16x32_bf16 v[20:23], a[24:27], v[44:47], v[20:23]
buffer_load_dwordx4 a[24:27], v6, s[32:35], s62 offen nt
s_waitcnt vmcnt(23)
v_mfma_f32_16x16x32_bf16 v[24:27], a[28:31], v[44:47], v[24:27]
buffer_load_dwordx4 a[28:31], v6, s[36:39], s62 offen nt
s_add_u32 s62, s62, 73728
ds_read_b32 v48, v10 offset:128
ds_read_b32 v49, v10 offset:160
ds_read_b32 v50, v10 offset:192
ds_read_b32 v51, v10 offset:224
s_waitcnt lgkmcnt(0)
v_and_b32 v44, v48, v2
v_and_b32 v45, v48, v3
v_and_b32 v46, v48, v4
v_and_b32 v47, v48, v5
s_waitcnt vmcnt(23)
s_nop 0
v_mfma_f32_16x16x32_bf16 v[20:23], a[32:35], v[44:47], v[20:23]
buffer_load_dwordx4 a[32:35], v6, s[32:35], s62 offen nt
s_waitcnt vmcnt(23)
v_mfma_f32_16x16x32_bf16 v[24:27], a[36:39], v[44:47], v[24:27]
buffer_load_dwordx4 a[36:39], v6, s[36:39], s62 offen nt
s_add_u32 s62, s62, 73728
v_and_b32 v44, v49, v2
v_and_b32 v45, v49, v3
v_and_b32 v46, v49, v4
v_and_b32 v47, v49, v5
s_waitcnt vmcnt(23)
s_nop 0
v_mfma_f32_16x16x32_bf16 v[20:23], a[40:43], v[44:47], v[20:23]
buffer_load_dwordx4 a[40:43], v6, s[32:35], s62 offen nt
s_waitcnt vmcnt(23)
v_mfma_f32_16x16x32_bf16 v[24:27], a[44:47], v[44:47], v[24:27]
buffer_load_dwordx4 a[44:47], v6, s[36:39], s62 offen nt
s_add_u32 s62, s62, 73728
v_and_b32 v44, v50, v2
v_and_b32 v45, v50, v3
v_and_b32 v46, v50, v4
v_and_b32 v47, v50, v5
s_waitcnt vmcnt(23)
s_nop 0
v_mfma_f32_16x16x32_bf16 v[20:23], a[48:51], v[44:47], v[20:23]
buffer_load_dwordx4 a[48:51], v6, s[32:35], s62 offen nt
s_waitcnt vmcnt(23)
v_mfma_f32_16x16x32_bf16 v[24:27], a[52:55], v[44:47], v[24:27]
buffer_load_dwordx4 a[52:55], v6, s[36:39], s62 offen nt
s_add_u32 s62, s62, 73728
v_and_b32 v44, v51, v2
v_and_b32 v45, v51, v3
v_and_b32 v46, v51, v4
v_and_b32 v47, v51, v5
s_waitcnt vmcnt(23)
s_nop 0
v_mfma_f32_16x16x32_bf16 v[20:23], a[56:59], v[44:47], v[20:23]
buffer_load_dwordx4 a[56:59], v6, s[32:35], s62 offen nt
s_waitcnt vmcnt(23)
v_mfma_f32_16x16x32_bf16 v[24:27], a[60:63], v[44:47], v[24:27]
buffer_load_dwordx4 a[60:63], v6, s[36:39], s62 offen nt
s_add_u32 s62, s62, 73728
ds_read_b32 v48, v10 offset:256
ds_read_b32 v49, v10 offset:288
ds_read_b32 v50, v10 offset:320
ds_read_b32 v51, v10 offset:352
s_waitcnt lgkmcnt(0)
v_and_b32 v44, v48, v2
v_and_b32 v45, v48, v3
v_and_b32 v46, v48, v4
v_and_b32 v47, v48, v5
s_waitcnt vmcnt(23)
s_nop 0
v_mfma_f32_16x16x32_bf16 v[20:23], a[64:67], v[44:47], v[20:23]
buffer_load_dwordx4 a[64:67], v6, s[32:35], s62 offen nt
s_waitcnt vmcnt(23)
v_mfma_f32_16x16x32_bf16 v[24:27], a[68:71], v[44:47], v[24:27]
buffer_load_dwordx4 a[68:71], v6, s[36:39], s62 offen nt
s_add_u32 s62, s62, 73728
v_and_b32 v44, v49, v2
v_and_b32 v45, v49, v3
v_and_b32 v46, v49, v4
v_and_b32 v47, v49, v5
s_waitcnt vmcnt(23)
s_nop 0
v_mfma_f32_16x16x32_bf16 v[20:23], a[72:75], v[44:47], v[20:23]
buffer_load_dwordx4 a[72:75], v6, s[32:35], s62 offen nt
s_waitcnt vmcnt(23)
v_mfma_f32_16x16x32_bf16 v[24:27], a[76:79], v[44:47], v[24:27]
buffer_load_dwordx4 a[76:79], v6, s[36:39], s62 offen nt
s_add_u32 s62, s62, 73728
v_and_b32 v44, v50, v2
v_and_b32 v45, v50, v3
v_and_b32 v46, v50, v4
v_and_b32 v47, v50, v5
s_waitcnt vmcnt(23)
s_nop 0
v_mfma_f32_16x16x32_bf16 v[20:23], a[80:83], v[44:47], v[20:23]
buffer_load_dwordx4 a[80:83], v6, s[32:35], s62 offen nt
s_waitcnt vmcnt(23)
v_mfma_f32_16x16x32_bf16 v[24:27], a[84:87], v[44:47], v[24:27]
buffer_load_dwordx4 a[84:87], v6, s[36:39], s62 offen nt
s_add_u32 s62, s62, 73728
v_and_b32 v44, v51, v2
v_and_b32 v45, v51, v3
v_and_b32 v46, v51, v4
v_and_b32 v47, v51, v5
s_waitcnt vmcnt(23)
s_nop 0
v_mfma_f32_16x16x32_bf16 v[20:23], a[88:91], v[44:47], v[20:23]
buffer_load_dwordx4 a[88:91], v6, s[32:35], s62 offen nt
s_waitcnt vmcnt(23)
v_mfma_f32_16x16x32_bf16 v[24:27], a[92:95], v[44:47], v[24:27]
buffer_load_dwordx4 a[92:95], v6, s[36:39], s62 offen nt
s_add_u32 s62, s62, 73728
ds_read_b32 v48, v10 offset:384
ds_read_b32 v49, v10 offset:416
ds_read_b32 v50, v10 offset:448
ds_read_b32 v51, v10 offset:480
s_waitcnt lgkmcnt(0)
v_and_b32 v44, v48, v2
v_and_b32 v45, v48, v3
v_and_b32 v46, v48, v4
v_and_b32 v47, v48, v5
s_waitcnt vmcnt(23)
s_nop 0
v_mfma_f32_16x16x32_bf16 v[20:23], a[0:3], v[44:47], v[20:23]
buffer_load_dwordx4 a[0:3], v7, s[48:51], s63 offen offset:0 nt
s_waitcnt vmcnt(23)
v_mfma_f32_16x16x32_bf16 v[24:27], a[4:7], v[44:47], v[24:27]
buffer_load_dwordx4 a[4:7], v7, s[48:51], s63 offen offset:128 nt
v_and_b32 v44, v49, v2
v_and_b32 v45, v49, v3
v_and_b32 v46, v49, v4
v_and_b32 v47, v49, v5
s_waitcnt vmcnt(23)
s_nop 0
v_mfma_f32_16x16x32_bf16 v[20:23], a[8:11], v[44:47], v[20:23]
buffer_load_dwordx4 a[8:11], v7, s[48:51], s63 offen offset:256 nt
s_add_u32 s63, s63, 9216
s_waitcnt vmcnt(23)
v_mfma_f32_16x16x32_bf16 v[24:27], a[12:15], v[44:47], v[24:27]
buffer_load_dwordx4 a[12:15], v7, s[48:51], s63 offen offset:0 nt
v_and_b32 v44, v50, v2
v_and_b32 v45, v50, v3
v_and_b32 v46, v50, v4
v_and_b32 v47, v50, v5
s_waitcnt vmcnt(23)
s_nop 0
v_mfma_f32_16x16x32_bf16 v[20:23], a[16:19], v[44:47], v[20:23]
buffer_load_dwordx4 a[16:19], v7, s[48:51], s63 offen offset:128 nt
s_waitcnt vmcnt(23)
v_mfma_f32_16x16x32_bf16 v[24:27], a[20:23], v[44:47], v[24:27]
buffer_load_dwordx4 a[20:23], v7, s[48:51], s63 offen offset:256 nt
s_add_u32 s63, s63, 9216
v_and_b32 v44, v51, v2
v_and_b32 v45, v51, v3
v_and_b32 v46, v51, v4
v_and_b32 v47, v51, v5
s_waitcnt vmcnt(23)
s_nop 0
v_mfma_f32_16x16x32_bf16 v[20:23], a[24:27], v[44:47], v[20:23]
buffer_load_dwordx4 a[24:27], v7, s[48:51], s63 offen offset:0 nt
s_waitcnt vmcnt(23)
v_mfma_f32_16x16x32_bf16 v[24:27], a[28:31], v[44:47], v[24:27]
buffer_load_dwordx4 a[28:31], v7, s[48:51], s63 offen offset:128 nt
ds_read_b32 v48, v10 offset:512
ds_read_b32 v49, v10 offset:544
ds_read_b32 v50, v10 offset:576
ds_read_b32 v51, v10 offset:608
s_waitcnt lgkmcnt(0)
v_and_b32 v44, v48, v2
v_and_b32 v45, v48, v3
v_and_b32 v46, v48, v4
v_and_b32 v47, v48, v5
s_waitcnt vmcnt(23)
s_nop 0
v_mfma_f32_16x16x32_bf16 v[20:23], a[32:35], v[44:47], v[20:23]
buffer_load_dwordx4 a[32:35], v7, s[48:51], s63 offen offset:256 nt
s_add_u32 s63, s63, 9216
s_waitcnt vmcnt(23)
v_mfma_f32_16x16x32_bf16 v[24:27], a[36:39], v[44:47], v[24:27]
buffer_load_dwordx4 a[36:39], v7, s[48:51], s63 offen offset:0 nt
v_and_b32 v44, v49, v2
v_and_b32 v45, v49, v3
v_and_b32 v46, v49, v4
v_and_b32 v47, v49, v5
s_waitcnt vmcnt(23)
s_nop 0
v_mfma_f32_16x16x32_bf16 v[20:23], a[40:43], v[44:47], v[20:23]
buffer_load_dwordx4 a[40:43], v7, s[48:51], s63 offen offset:128 nt
s_waitcnt vmcnt(23)
v_mfma_f32_16x16x32_bf16 v[24:27], a[44:47], v[44:47], v[24:27]
buffer_load_dwordx4 a[44:47], v7, s[48:51], s63 offen offset:256 nt
s_add_u32 s63, s63, 9216
v_and_b32 v44, v50, v2
v_and_b32 v45, v50, v3
v_and_b32 v46, v50, v4
v_and_b32 v47, v50, v5
s_waitcnt vmcnt(23)
s_nop 0
v_mfma_f32_16x16x32_bf16 v[20:23], a[48:51], v[44:47], v[20:23]
buffer_load_dwordx4 a[48:51], v7, s[48:51], s63 offen offset:0 nt
s_waitcnt vmcnt(23)
v_mfma_f32_16x16x32_bf16 v[24:27], a[52:55], v[44:47], v[24:27]
buffer_load_dwordx4 a[52:55], v7, s[48:51], s63 offen offset:128 nt
v_and_b32 v44, v51, v2
v_and_b32 v45, v51, v3
v_and_b32 v46, v51, v4
v_and_b32 v47, v51, v5
s_waitcnt vmcnt(23)
s_nop 0
v_mfma_f32_16x16x32_bf16 v[20:23], a[56:59], v[44:47], v[20:23]
buffer_load_dwordx4 a[56:59], v7, s[48:51], s63 offen offset:256 nt
s_add_u32 s63, s63, 9216
s_waitcnt vmcnt(23)
v_mfma_f32_16x16x32_bf16 v[24:27], a[60:63], v[44:47], v[24:27]
buffer_load_dwordx4 a[60:63], v7, s[48:51], s63 offen offset:0 nt
ds_read_b32 v48, v10 offset:640
ds_read_b32 v49, v10 offset:672
ds_read_b32 v50, v10 offset:704
ds_read_b32 v51, v10 offset:736
s_waitcnt lgkmcnt(0)
v_and_b32 v44, v48, v2
v_and_b32 v45, v48, v3
v_and_b32 v46, v48, v4
v_and_b32 v47, v48, v5
s_waitcnt vmcnt(23)
s_nop 0
v_mfma_f32_16x16x32_bf16 v[20:23], a[64:67], v[44:47], v[20:23]
buffer_load_dwordx4 a[64:67], v7, s[48:51], s63 offen offset:128 nt
s_waitcnt vmcnt(23)
v_mfma_f32_16x16x32_bf16 v[24:27], a[68:71], v[44:47], v[24:27]
buffer_load_dwordx4 a[68:71], v7, s[48:51], s63 offen offset:256 nt
s_add_u32 s63, s63, 9216
v_and_b32 v44, v49, v2
v_and_b32 v45, v49, v3
v_and_b32 v46, v49, v4
v_and_b32 v47, v49, v5
s_waitcnt vmcnt(23)
s_nop 0
v_mfma_f32_16x16x32_bf16 v[20:23], a[72:75], v[44:47], v[20:23]
buffer_load_dwordx4 a[72:75], v7, s[48:51], s63 offen offset:0 nt
s_waitcnt vmcnt(23)
v_mfma_f32_16x16x32_bf16 v[24:27], a[76:79], v[44:47], v[24:27]
buffer_load_dwordx4 a[76:79], v7, s[48:51], s63 offen offset:128 nt
v_and_b32 v44, v50, v2
v_and_b32 v45, v50, v3
v_and_b32 v46, v50, v4
v_and_b32 v47, v50, v5
s_waitcnt vmcnt(23)
s_nop 0
v_mfma_f32_16x16x32_bf16 v[20:23], a[80:83], v[44:47], v[20:23]
buffer_load_dwordx4 a[80:83], v7, s[48:51], s63 offen offset:256 nt
s_add_u32 s63, s63, 9216
s_waitcnt vmcnt(23)
v_mfma_f32_16x16x32_bf16 v[24:27], a[84:87], v[44:47], v[24:27]
buffer_load_dwordx4 a[84:87], v7, s[48:51], s63 offen offset:0 nt
v_and_b32 v44, v51, v2
v_and_b32 v45, v51, v3
v_and_b32 v46, v51, v4
v_and_b32 v47, v51, v5
s_waitcnt vmcnt(23)
s_nop 0
v_mfma_f32_16x16x32_bf16 v[20:23], a[88:91], v[44:47], v[20:23]
buffer_load_dwordx4 a[88:91], v7, s[48:51], s63 offen offset:128 nt
s_waitcnt vmcnt(23)
v_mfma_f32_16x16x32_bf16 v[24:27], a[92:95], v[44:47], v[24:27]
buffer_load_dwordx4 a[92:95], v7, s[48:51], s63 offen offset:256 nt
s_add_u32 s63, s63, 9216
s_lshl_b32 s6, s58, 11
v_add_u32 v8, s6, v121
s_nop 0
ds_write_b128 v8, v[20:23] offset:8192
s_nop 1
ds_write_b128 v8, v[24:27] offset:9216
v_mov_b32 v11, 1
s_waitcnt lgkmcnt(0)
s_mov_b64 exec, 1
ds_add_u32 v125, v11 offset:2824
s_mov_b64 exec, -1
s_mov_b32 s82, 0
L_sp_5:
ds_read_b32 v26, v125 offset:2824
s_waitcnt lgkmcnt(0)
v_readfirstlane_b32 s6, v26
s_nop 0
s_cmp_eq_u32 s6, 3
s_cbranch_scc1 L_spd_6
s_sleep 1
s_add_u32 s82, s82, 1
s_cmp_lt_u32 s82, 0x100000
s_cbranch_scc1 L_sp_5
s_branch L_exit
L_spd_6:
ds_read_b32 v48, v122 offset:8192
ds_read_b32 v49, v122 offset:8832
ds_read_b32 v50, v122 offset:9216
ds_read_b32 v51, v122 offset:9856
ds_read_b32 v52, v122 offset:10240
ds_read_b32 v53, v122 offset:10880
ds_read_b32 v54, v122 offset:11264
ds_read_b32 v55, v122 offset:11904
ds_read_b32 v56, v122 offset:12288
ds_read_b32 v57, v122 offset:12928
ds_read_b32 v58, v122 offset:13312
ds_read_b32 v59, v122 offset:13952
s_waitcnt lgkmcnt(0)
v_add_f32 v48, v48, v49
v_add_f32 v52, v52, v53
v_add_f32 v56, v56, v57
v_add_f32 v48, v48, v52
v_add_f32 v48, v48, v56
v_add_f32 v50, v50, v51
v_add_f32 v54, v54, v55
v_add_f32 v58, v58, v59
v_add_f32 v50, v50, v54
v_add_f32 v50, v50, v58
v_cvt_pk_bf16_f32 v48, v48, v48
v_and_b32 v48, s90, v48
v_cvt_pk_bf16_f32 v50, v50, v50
v_and_b32 v50, s90, v50
v_mul_f32 v52, v48, v48
v_mul_f32 v52, v52, v48
v_mul_f32 v52, 0x3d372713, v52
v_add_f32 v52, v48, v52
v_mul_f32 v52, 0x3f4c422a, v52
v_mul_f32 v52, 0xc038aa3b, v52
v_exp_f32 v52, v52
s_nop 0
v_add_f32 v52, 1.0, v52
v_rcp_f32 v52, v52
s_nop 0
v_mul_f32 v52, v48, v52
v_cvt_pk_bf16_f32 v52, v52, v52
v_and_b32 v52, s90, v52
v_mul_f32 v52, v52, v50
v_cvt_pk_bf16_f32 v52, v52, v52
s_lshl_b32 s6, s58, 8
v_add_u32 v8, s6, v120
ds_write_b32 v8, v52 offset:16384
v_lshlrev_b32 v8, 2, v124
v_add_u32 v8, s6, v8
ds_read_b32 v64, v8 offset:16384
ds_read_b32 v65, v8 offset:16416
ds_read_b32 v66, v8 offset:16448
ds_read_b32 v67, v8 offset:16480
ds_read_b32 v68, v8 offset:16512
ds_read_b32 v69, v8 offset:16544
ds_read_b32 v70, v8 offset:16576
ds_read_b32 v71, v8 offset:16608
s_waitcnt lgkmcnt(0)
v_and_b32 v44, v64, v2
v_and_b32 v45, v64, v3
v_and_b32 v46, v64, v4
v_and_b32 v47, v64, v5
s_waitcnt vmcnt(23)
s_nop 0
v_mfma_f32_16x16x32_bf16 v[28:31], a[0:3], v[44:47], v[28:31]
s_waitcnt vmcnt(22)
v_mfma_f32_16x16x32_bf16 v[32:35], a[4:7], v[44:47], v[32:35]
s_waitcnt vmcnt(21)
v_mfma_f32_16x16x32_bf16 v[36:39], a[8:11], v[44:47], v[36:39]
v_and_b32 v44, v65, v2
v_and_b32 v45, v65, v3
v_and_b32 v46, v65, v4
v_and_b32 v47, v65, v5
s_waitcnt vmcnt(20)
s_nop 0
v_mfma_f32_16x16x32_bf16 v[28:31], a[12:15], v[44:47], v[28:31]
s_waitcnt vmcnt(19)
v_mfma_f32_16x16x32_bf16 v[32:35], a[16:19], v[44:47], v[32:35]
s_waitcnt vmcnt(18)
v_mfma_f32_16x16x32_bf16 v[36:39], a[20:23], v[44:47], v[36:39]
v_and_b32 v44, v66, v2
v_and_b32 v45, v66, v3
v_and_b32 v46, v66, v4
v_and_b32 v47, v66, v5
s_waitcnt vmcnt(17)
s_nop 0
v_mfma_f32_16x16x32_bf16 v[28:31], a[24:27], v[44:47], v[28:31]
s_waitcnt vmcnt(16)
v_mfma_f32_16x16x32_bf16 v[32:35], a[28:31], v[44:47], v[32:35]
s_waitcnt vmcnt(15)
v_mfma_f32_16x16x32_bf16 v[36:39], a[32:35], v[44:47], v[36:39]
v_and_b32 v44, v67, v2
v_and_b32 v45, v67, v3
v_and_b32 v46, v67, v4
v_and_b32 v47, v67, v5
s_waitcnt vmcnt(14)
s_nop 0
v_mfma_f32_16x16x32_bf16 v[28:31], a[36:39], v[44:47], v[28:31]
s_waitcnt vmcnt(13)
v_mfma_f32_16x16x32_bf16 v[32:35], a[40:43], v[44:47], v[32:35]
s_waitcnt vmcnt(12)
v_mfma_f32_16x16x32_bf16 v[36:39], a[44:47], v[44:47], v[36:39]
v_and_b32 v44, v68, v2
v_and_b32 v45, v68, v3
v_and_b32 v46, v68, v4
v_and_b32 v47, v68, v5
s_waitcnt vmcnt(11)
s_nop 0
v_mfma_f32_16x16x32_bf16 v[28:31], a[48:51], v[44:47], v[28:31]
s_waitcnt vmcnt(10)
v_mfma_f32_16x16x32_bf16 v[32:35], a[52:55], v[44:47], v[32:35]
s_waitcnt vmcnt(9)
v_mfma_f32_16x16x32_bf16 v[36:39], a[56:59], v[44:47], v[36:39]
v_and_b32 v44, v69, v2
v_and_b32 v45, v69, v3
v_and_b32 v46, v69, v4
v_and_b32 v47, v69, v5
s_waitcnt vmcnt(8)
s_nop 0
v_mfma_f32_16x16x32_bf16 v[28:31], a[60:63], v[44:47], v[28:31]
s_waitcnt vmcnt(7)
v_mfma_f32_16x16x32_bf16 v[32:35], a[64:67], v[44:47], v[32:35]
s_waitcnt vmcnt(6)
v_mfma_f32_16x16x32_bf16 v[36:39], a[68:71], v[44:47], v[36:39]
v_and_b32 v44, v70, v2
v_and_b32 v45, v70, v3
v_and_b32 v46, v70, v4
v_and_b32 v47, v70, v5
s_waitcnt vmcnt(5)
s_nop 0
v_mfma_f32_16x16x32_bf16 v[28:31], a[72:75], v[44:47], v[28:31]
s_waitcnt vmcnt(4)
v_mfma_f32_16x16x32_bf16 v[32:35], a[76:79], v[44:47], v[32:35]
s_waitcnt vmcnt(3)
v_mfma_f32_16x16x32_bf16 v[36:39], a[80:83], v[44:47], v[36:39]
v_and_b32 v44, v71, v2
v_and_b32 v45, v71, v3
v_and_b32 v46, v71, v4
v_and_b32 v47, v71, v5
s_waitcnt vmcnt(2)
s_nop 0
v_mfma_f32_16x16x32_bf16 v[28:31], a[84:87], v[44:47], v[28:31]
s_waitcnt vmcnt(1)
v_mfma_f32_16x16x32_bf16 v[32:35], a[88:91], v[44:47], v[32:35]
s_waitcnt vmcnt(0)
v_mfma_f32_16x16x32_bf16 v[36:39], a[92:95], v[44:47], v[36:39]
s_mul_i32 s6, s58, 3072
v_add_u32 v8, s6, v121
v_add_u32 v9, s6, v122
s_nop 0
ds_write_b128 v8, v[28:31] offset:17408
s_nop 0
ds_write_b128 v8, v[32:35] offset:18432
s_nop 0
ds_write_b128 v8, v[36:39] offset:19456
ds_read_b32 v48, v9 offset:17408
ds_read_b32 v49, v9 offset:18048
ds_read_b32 v50, v9 offset:18432
ds_read_b32 v51, v9 offset:19072
ds_read_b32 v52, v9 offset:19456
ds_read_b32 v53, v9 offset:20096
s_waitcnt lgkmcnt(0)
s_mul_i32 s6, s57, 2304
s_mul_i32 s7, s58, 768
s_add_u32 s6, s6, s7
s_add_u32 s6, s6, 0x71000
v_add_f32 v48, v48, v49
buffer_store_dword v48, v120, s[40:43], s6 offen offset:0 sc1
v_add_f32 v50, v50, v51
buffer_store_dword v50, v120, s[40:43], s6 offen offset:256 sc1
v_add_f32 v52, v52, v53
buffer_store_dword v52, v120, s[40:43], s6 offen offset:512 sc1
s_branch L_preB1
L_stream:
s_lshl_b32 s6, s4, 24
s_add_u32 s32, s10, s6
s_addc_u32 s33, s11, 0
s_mov_b32 s34, 0x1000000
s_mov_b32 s35, 0x20000
s_add_u32 s36, s12, s6
s_addc_u32 s37, s13, 0
s_mov_b32 s38, 0x1000000
s_mov_b32 s39, 0x20000
s_sub_u32 s58, s3, 4
s_barrier
s_mov_b32 s64, 0x903a9000
s_mov_b32 s65, 0x90ae9074
s_mov_b32 s66, 0x912290e8
s_mov_b32 s67, 0x9196915c
s_mov_b32 s68, 0x920a91d0
s_mov_b32 s69, 0x62786244
s_mov_b32 s70, 0x5ae062ac
s_mov_b32 s71, 0x93465b13
s_mov_b32 s72, 0x903a9000
s_mov_b32 s73, 0x90ae9074
s_mov_b32 s74, 0x912290e8
s_mov_b32 s75, 0x9196915c
s_mov_b32 s76, 0x8a0989d0
s_mov_b32 s77, 0x5a755a42
s_mov_b32 s78, 0x5adb5aa8
s_mov_b32 s79, 0x8b478b0e
s_lshr_b32 s6, s4, 3
s_lshl_b32 s6, s6, 4
s_add_u32 s6, s6, s5
s_lshr_b32 s7, s6, 1
s_mov_b32 m0, s7
s_and_b32 s6, s6, 1
s_lshl_b32 s6, s6, 4
s_movrels_b32 s7, s64
s_lshr_b32 s7, s7, s6
s_and_b32 s62, s7, 0x7ff
s_bfe_u32 s67, s7, 0x5000b
s_add_u32 s67, s67, 40
s_lshl_b32 s61, s62, 14
s_lshl_b32 s60, s58, 12
s_add_u32 s60, s60, s61
s_lshl_b32 s67, s67, 2
v_lshlrev_b32 v1, 4, v0
buffer_load_dwordx4 v[64:67], v1, s[32:35], s60 offen offset:0 nt
buffer_load_dwordx4 v[68:71], v1, s[32:35], s60 offen offset:1024 nt
buffer_load_dwordx4 v[72:75], v1, s[32:35], s60 offen offset:2048 nt
buffer_load_dwordx4 v[76:79], v1, s[32:35], s60 offen offset:3072 nt
buffer_load_dwordx4 a[0:3], v1, s[36:39], s60 offen offset:0 nt
buffer_load_dwordx4 a[4:7], v1, s[36:39], s60 offen offset:1024 nt
buffer_load_dwordx4 a[8:11], v1, s[36:39], s60 offen offset:2048 nt
buffer_load_dwordx4 a[12:15], v1, s[36:39], s60 offen offset:3072 nt
s_mov_b32 s70, s60
s_add_u32 s60, s60, 16384
buffer_load_dwordx4 v[80:83], v1, s[32:35], s60 offen offset:0 nt
buffer_load_dwordx4 v[84:87], v1, s[32:35], s60 offen offset:1024 nt
buffer_load_dwordx4 v[88:91], v1, s[32:35], s60 offen offset:2048 nt
buffer_load_dwordx4 v[92:95], v1, s[32:35], s60 offen offset:3072 nt
buffer_load_dwordx4 a[16:19], v1, s[36:39], s60 offen offset:0 nt
buffer_load_dwordx4 a[20:23], v1, s[36:39], s60 offen offset:1024 nt
buffer_load_dwordx4 a[24:27], v1, s[36:39], s60 offen offset:2048 nt
buffer_load_dwordx4 a[28:31], v1, s[36:39], s60 offen offset:3072 nt
s_mov_b32 s71, s60
s_add_u32 s60, s60, 16384
buffer_load_dwordx4 v[96:99], v1, s[32:35], s60 offen offset:0 nt
buffer_load_dwordx4 v[100:103], v1, s[32:35], s60 offen offset:1024 nt
buffer_load_dwordx4 v[104:107], v1, s[32:35], s60 offen offset:2048 nt
buffer_load_dwordx4 v[108:111], v1, s[32:35], s60 offen offset:3072 nt
buffer_load_dwordx4 a[32:35], v1, s[36:39], s60 offen offset:0 nt
buffer_load_dwordx4 a[36:39], v1, s[36:39], s60 offen offset:1024 nt
buffer_load_dwordx4 a[40:43], v1, s[36:39], s60 offen offset:2048 nt
buffer_load_dwordx4 a[44:47], v1, s[36:39], s60 offen offset:3072 nt
s_mov_b32 s72, s60
s_add_u32 s60, s60, 16384
buffer_load_dwordx4 v[112:115], v1, s[32:35], s60 offen offset:0 nt
buffer_load_dwordx4 v[116:119], v1, s[32:35], s60 offen offset:1024 nt
buffer_load_dwordx4 v[120:123], v1, s[32:35], s60 offen offset:2048 nt
buffer_load_dwordx4 v[124:127], v1, s[32:35], s60 offen offset:3072 nt
buffer_load_dwordx4 a[48:51], v1, s[36:39], s60 offen offset:0 nt
buffer_load_dwordx4 a[52:55], v1, s[36:39], s60 offen offset:1024 nt
buffer_load_dwordx4 a[56:59], v1, s[36:39], s60 offen offset:2048 nt
buffer_load_dwordx4 a[60:63], v1, s[36:39], s60 offen offset:3072 nt
s_mov_b32 s73, s60
s_add_u32 s60, s60, 16384
buffer_load_dwordx4 v[128:131], v1, s[32:35], s60 offen offset:0 nt
buffer_load_dwordx4 v[132:135], v1, s[32:35], s60 offen offset:1024 nt
buffer_load_dwordx4 v[136:139], v1, s[32:35], s60 offen offset:2048 nt
buffer_load_dwordx4 v[140:143], v1, s[32:35], s60 offen offset:3072 nt
buffer_load_dwordx4 a[64:67], v1, s[36:39], s60 offen offset:0 nt
buffer_load_dwordx4 a[68:71], v1, s[36:39], s60 offen offset:1024 nt
buffer_load_dwordx4 a[72:75], v1, s[36:39], s60 offen offset:2048 nt
buffer_load_dwordx4 a[76:79], v1, s[36:39], s60 offen offset:3072 nt
s_mov_b32 s74, s60
s_add_u32 s60, s60, 16384
buffer_load_dwordx4 v[144:147], v1, s[32:35], s60 offen offset:0 nt
buffer_load_dwordx4 v[148:151], v1, s[32:35], s60 offen offset:1024 nt
buffer_load_dwordx4 v[152:155], v1, s[32:35], s60 offen offset:2048 nt
buffer_load_dwordx4 v[156:159], v1, s[32:35], s60 offen offset:3072 nt
buffer_load_dwordx4 a[80:83], v1, s[36:39], s60 offen offset:0 nt
buffer_load_dwordx4 a[84:87], v1, s[36:39], s60 offen offset:1024 nt
buffer_load_dwordx4 a[88:91], v1, s[36:39], s60 offen offset:2048 nt
buffer_load_dwordx4 a[92:95], v1, s[36:39], s60 offen offset:3072 nt
s_mov_b32 s75, s60
s_add_u32 s60, s60, 16384
v_mov_b32 v19, 0
s_mov_b32 s82, 0
L_sp_7:
ds_read_b32 v62, v19 offset:2816
s_waitcnt lgkmcnt(0)
v_readfirstlane_b32 s6, v62
s_nop 0
s_cmp_eq_u32 s6, 1
s_cbranch_scc1 L_spd_8
s_sleep 1
s_add_u32 s82, s82, 1
s_cmp_lt_u32 s82, 0x100000
s_cbranch_scc1 L_sp_7
s_branch L_exit
L_spd_8:
v_and_b32 v62, 15, v0
v_lshlrev_b32 v62, 4, v62
ds_read_b128 v[6:9], v62 offset:2304
ds_read_b128 v[10:13], v62 offset:2560
v_mov_b32 v14, 0xf149f2ca
v_mov_b32 v16, 0xf149f2ca
v_mov_b32 v17, 0
v_mov_b32 v20, 0
v_mov_b32 v21, 0
v_mov_b32 v22, 0
v_mov_b32 v23, 0
s_mov_b32 s64, 0x1000000
s_mov_b32 s66, 2
s_mov_b32 s65, 0
s_waitcnt lgkmcnt(0)
L_loop:
s_cmp_ge_u32 s70, s64
s_cbranch_scc1 L_loop_end
s_cmp_ge_u32 s65, s64
s_cbranch_scc1 L_notk_0
s_cmp_lt_u32 s66, 6
s_cbranch_scc1 L_notk_0
v_mov_b32 v62, 0
v_mov_b32 v63, 1
s_mov_b64 exec, 1
ds_add_rtn_u32 v63, v62, v63 offset:27648
s_mov_b64 exec, -1
L_notk_0:
s_waitcnt vmcnt(12)
v_dot2_f32_bf16 v24, v64, v6, 0
v_dot2_f32_bf16 v28, v64, v10, 0
v_dot2_f32_bf16 v25, v68, v6, 0
v_dot2_f32_bf16 v29, v68, v10, 0
v_dot2_f32_bf16 v26, v72, v6, 0
v_dot2_f32_bf16 v30, v72, v10, 0
v_dot2_f32_bf16 v27, v76, v6, 0
v_dot2_f32_bf16 v31, v76, v10, 0
v_dot2c_f32_bf16 v24, v65, v7
v_dot2c_f32_bf16 v28, v65, v11
v_dot2c_f32_bf16 v25, v69, v7
v_dot2c_f32_bf16 v29, v69, v11
v_dot2c_f32_bf16 v26, v73, v7
v_dot2c_f32_bf16 v30, v73, v11
v_dot2c_f32_bf16 v27, v77, v7
v_dot2c_f32_bf16 v31, v77, v11
v_dot2c_f32_bf16 v24, v66, v8
v_dot2c_f32_bf16 v28, v66, v12
v_dot2c_f32_bf16 v25, v70, v8
v_dot2c_f32_bf16 v29, v70, v12
v_dot2c_f32_bf16 v26, v74, v8
v_dot2c_f32_bf16 v30, v74, v12
v_dot2c_f32_bf16 v27, v78, v8
v_dot2c_f32_bf16 v31, v78, v12
v_dot2c_f32_bf16 v24, v67, v9
v_dot2c_f32_bf16 v28, v67, v13
v_dot2c_f32_bf16 v25, v71, v9
v_dot2c_f32_bf16 v29, v71, v13
v_dot2c_f32_bf16 v26, v75, v9
v_dot2c_f32_bf16 v30, v75, v13
v_dot2c_f32_bf16 v27, v79, v9
v_dot2c_f32_bf16 v31, v79, v13
s_cmp_lt_u32 s66, 6
s_cbranch_scc1 L_skipK_0
s_cmp_ge_u32 s65, s64
s_cbranch_scc1 L_back_0
s_waitcnt lgkmcnt(0)
v_readfirstlane_b32 s6, v63
s_nop 0
s_cmp_lt_u32 s6, s67
s_cbranch_scc0 L_dyn_0
s_lshl_b32 s65, s6, 12
s_add_u32 s65, s65, s61
L_back_0:
s_mov_b32 s72, s65
buffer_load_dwordx4 v[96:99], v1, s[32:35], s65 offen offset:0 nt
buffer_load_dwordx4 v[100:103], v1, s[32:35], s65 offen offset:1024 nt
buffer_load_dwordx4 v[104:107], v1, s[32:35], s65 offen offset:2048 nt
buffer_load_dwordx4 v[108:111], v1, s[32:35], s65 offen offset:3072 nt
L_skipK_0:
v_add_f32_dpp v24, v24, v24 row_ror:8 row_mask:0xf bank_mask:0x3
v_add_f32_dpp v25, v25, v25 row_ror:8 row_mask:0xf bank_mask:0x3
v_add_f32_dpp v26, v26, v26 row_ror:8 row_mask:0xf bank_mask:0x3
v_add_f32_dpp v27, v27, v27 row_ror:8 row_mask:0xf bank_mask:0x3
v_add_f32_dpp v24, v28, v28 row_ror:8 row_mask:0xf bank_mask:0xc
v_add_f32_dpp v25, v29, v29 row_ror:8 row_mask:0xf bank_mask:0xc
v_add_f32_dpp v26, v30, v30 row_ror:8 row_mask:0xf bank_mask:0xc
v_add_f32_dpp v27, v31, v31 row_ror:8 row_mask:0xf bank_mask:0xc
v_add_f32_dpp v24, v24, v24 row_half_mirror row_mask:0xf bank_mask:0xf
v_add_f32_dpp v25, v25, v25 row_half_mirror row_mask:0xf bank_mask:0xf
v_add_f32_dpp v26, v26, v26 row_half_mirror row_mask:0xf bank_mask:0xf
v_add_f32_dpp v27, v27, v27 row_half_mirror row_mask:0xf bank_mask:0xf
v_add_f32_dpp v24, v24, v24 quad_perm:[1,0,3,2] row_mask:0xf bank_mask:0xf
v_add_f32_dpp v25, v25, v25 quad_perm:[1,0,3,2] row_mask:0xf bank_mask:0xf
v_add_f32_dpp v26, v26, v26 quad_perm:[1,0,3,2] row_mask:0xf bank_mask:0xf
v_add_f32_dpp v27, v27, v27 quad_perm:[1,0,3,2] row_mask:0xf bank_mask:0xf
v_add_f32_dpp v24, v24, v24 quad_perm:[2,3,0,1] row_mask:0xf bank_mask:0xf
v_add_f32_dpp v25, v25, v25 quad_perm:[2,3,0,1] row_mask:0xf bank_mask:0xf
v_add_f32_dpp v26, v26, v26 quad_perm:[2,3,0,1] row_mask:0xf bank_mask:0xf
v_add_f32_dpp v27, v27, v27 quad_perm:[2,3,0,1] row_mask:0xf bank_mask:0xf
v_cvt_pk_bf16_f32 v52, v24, v25
v_cvt_pk_bf16_f32 v53, v26, v27
v_lshlrev_b32 v48, 16, v52
v_and_b32 v49, s90, v52
v_lshlrev_b32 v50, 16, v53
v_and_b32 v51, s90, v53
v_mul_f32 v48, s89, v48
v_mul_f32 v49, s89, v49
v_mul_f32 v50, s89, v50
v_mul_f32 v51, s89, v51
v_cvt_pk_bf16_f32 v52, v48, v49
v_cvt_pk_bf16_f32 v53, v50, v51
v_lshlrev_b32 v54, 16, v52
v_and_b32 v55, s90, v52
v_lshlrev_b32 v56, 16, v53
v_and_b32 v57, s90, v53
v_max3_f32 v19, v54, v55, v56
v_max3_f32 v19, v19, v57, v14
v_mov_b32 v62, v19
s_nop 0
s_nop 0
v_permlane16_swap_b32 v19, v62
v_max_f32 v19, v19, v62
v_mov_b32 v62, v19
s_nop 0
s_nop 0
v_permlane32_swap_b32 v19, v62
v_max_f32 v14, v19, v62
v_mul_f32 v15, s88, v14
v_sub_f32 v18, v16, v15
v_fma_f32 v54, v54, s88, -v15
v_fma_f32 v55, v55, s88, -v15
v_fma_f32 v56, v56, s88, -v15
v_fma_f32 v57, v57, s88, -v15
v_exp_f32 v18, v18
v_exp_f32 v54, v54
v_exp_f32 v55, v55
v_exp_f32 v56, v56
v_exp_f32 v57, v57
v_mov_b32 v16, v15
v_cvt_pk_bf16_f32 v58, v54, v54
v_cvt_pk_bf16_f32 v59, v55, v55
v_cvt_pk_bf16_f32 v60, v56, v56
v_cvt_pk_bf16_f32 v61, v57, v57
v_add_f32 v19, v54, v55
v_add_f32 v62, v56, v57
v_mul_f32 v20, v20, v18
v_mul_f32 v21, v21, v18
v_mul_f32 v22, v22, v18
v_mul_f32 v23, v23, v18
v_add_f32 v19, v19, v62
v_and_b32 v32, v58, v2
v_and_b32 v33, v58, v3
v_and_b32 v34, v58, v4
v_and_b32 v35, v58, v5
v_and_b32 v36, v59, v2
v_and_b32 v37, v59, v3
v_and_b32 v38, v59, v4
v_and_b32 v39, v59, v5
v_and_b32 v40, v60, v2
v_and_b32 v41, v60, v3
v_and_b32 v42, v60, v4
v_and_b32 v43, v60, v5
v_and_b32 v44, v61, v2
v_and_b32 v45, v61, v3
v_and_b32 v46, v61, v4
v_and_b32 v47, v61, v5
v_fma_f32 v17, v17, v18, v19
s_waitcnt vmcnt(12)
v_mfma_f32_16x16x32_bf16 v[20:23], a[0:3], v[32:35], v[20:23]
v_mfma_f32_16x16x32_bf16 v[20:23], a[4:7], v[36:39], v[20:23]
v_mfma_f32_16x16x32_bf16 v[20:23], a[8:11], v[40:43], v[20:23]
v_mfma_f32_16x16x32_bf16 v[20:23], a[12:15], v[44:47], v[20:23]
s_cmp_lt_u32 s66, 6
s_cbranch_scc1 L_skipV_0
buffer_load_dwordx4 a[32:35], v1, s[36:39], s65 offen offset:0 nt
buffer_load_dwordx4 a[36:39], v1, s[36:39], s65 offen offset:1024 nt
buffer_load_dwordx4 a[40:43], v1, s[36:39], s65 offen offset:2048 nt
buffer_load_dwordx4 a[44:47], v1, s[36:39], s65 offen offset:3072 nt
L_skipV_0:
s_add_u32 s66, s66, 1
s_cmp_ge_u32 s71, s64
s_cbranch_scc1 L_loop_end
s_cmp_ge_u32 s65, s64
s_cbranch_scc1 L_notk_1
s_cmp_lt_u32 s66, 6
s_cbranch_scc1 L_notk_1
v_mov_b32 v62, 0
v_mov_b32 v63, 1
s_mov_b64 exec, 1
ds_add_rtn_u32 v63, v62, v63 offset:27648
s_mov_b64 exec, -1
L_notk_1:
s_waitcnt vmcnt(12)
v_dot2_f32_bf16 v24, v80, v6, 0
v_dot2_f32_bf16 v28, v80, v10, 0
v_dot2_f32_bf16 v25, v84, v6, 0
v_dot2_f32_bf16 v29, v84, v10, 0
v_dot2_f32_bf16 v26, v88, v6, 0
v_dot2_f32_bf16 v30, v88, v10, 0
v_dot2_f32_bf16 v27, v92, v6, 0
v_dot2_f32_bf16 v31, v92, v10, 0
v_dot2c_f32_bf16 v24, v81, v7
v_dot2c_f32_bf16 v28, v81, v11
v_dot2c_f32_bf16 v25, v85, v7
v_dot2c_f32_bf16 v29, v85, v11
v_dot2c_f32_bf16 v26, v89, v7
v_dot2c_f32_bf16 v30, v89, v11
v_dot2c_f32_bf16 v27, v93, v7
v_dot2c_f32_bf16 v31, v93, v11
v_dot2c_f32_bf16 v24, v82, v8
v_dot2c_f32_bf16 v28, v82, v12
v_dot2c_f32_bf16 v25, v86, v8
v_dot2c_f32_bf16 v29, v86, v12
v_dot2c_f32_bf16 v26, v90, v8
v_dot2c_f32_bf16 v30, v90, v12
v_dot2c_f32_bf16 v27, v94, v8
v_dot2c_f32_bf16 v31, v94, v12
v_dot2c_f32_bf16 v24, v83, v9
v_dot2c_f32_bf16 v28, v83, v13
v_dot2c_f32_bf16 v25, v87, v9
v_dot2c_f32_bf16 v29, v87, v13
v_dot2c_f32_bf16 v26, v91, v9
v_dot2c_f32_bf16 v30, v91, v13
v_dot2c_f32_bf16 v27, v95, v9
v_dot2c_f32_bf16 v31, v95, v13
s_cmp_lt_u32 s66, 6
s_cbranch_scc1 L_skipK_1
s_cmp_ge_u32 s65, s64
s_cbranch_scc1 L_back_1
s_waitcnt lgkmcnt(0)
v_readfirstlane_b32 s6, v63
s_nop 0
s_cmp_lt_u32 s6, s67
s_cbranch_scc0 L_dyn_1
s_lshl_b32 s65, s6, 12
s_add_u32 s65, s65, s61
L_back_1:
s_mov_b32 s73, s65
buffer_load_dwordx4 v[112:115], v1, s[32:35], s65 offen offset:0 nt
buffer_load_dwordx4 v[116:119], v1, s[32:35], s65 offen offset:1024 nt
buffer_load_dwordx4 v[120:123], v1, s[32:35], s65 offen offset:2048 nt
buffer_load_dwordx4 v[124:127], v1, s[32:35], s65 offen offset:3072 nt
L_skipK_1:
v_add_f32_dpp v24, v24, v24 row_ror:8 row_mask:0xf bank_mask:0x3
v_add_f32_dpp v25, v25, v25 row_ror:8 row_mask:0xf bank_mask:0x3
v_add_f32_dpp v26, v26, v26 row_ror:8 row_mask:0xf bank_mask:0x3
v_add_f32_dpp v27, v27, v27 row_ror:8 row_mask:0xf bank_mask:0x3
v_add_f32_dpp v24, v28, v28 row_ror:8 row_mask:0xf bank_mask:0xc
v_add_f32_dpp v25, v29, v29 row_ror:8 row_mask:0xf bank_mask:0xc
v_add_f32_dpp v26, v30, v30 row_ror:8 row_mask:0xf bank_mask:0xc
v_add_f32_dpp v27, v31, v31 row_ror:8 row_mask:0xf bank_mask:0xc
v_add_f32_dpp v24, v24, v24 row_half_mirror row_mask:0xf bank_mask:0xf
v_add_f32_dpp v25, v25, v25 row_half_mirror row_mask:0xf bank_mask:0xf
v_add_f32_dpp v26, v26, v26 row_half_mirror row_mask:0xf bank_mask:0xf
v_add_f32_dpp v27, v27, v27 row_half_mirror row_mask:0xf bank_mask:0xf
v_add_f32_dpp v24, v24, v24 quad_perm:[1,0,3,2] row_mask:0xf bank_mask:0xf
v_add_f32_dpp v25, v25, v25 quad_perm:[1,0,3,2] row_mask:0xf bank_mask:0xf
v_add_f32_dpp v26, v26, v26 quad_perm:[1,0,3,2] row_mask:0xf bank_mask:0xf
v_add_f32_dpp v27, v27, v27 quad_perm:[1,0,3,2] row_mask:0xf bank_mask:0xf
v_add_f32_dpp v24, v24, v24 quad_perm:[2,3,0,1] row_mask:0xf bank_mask:0xf
v_add_f32_dpp v25, v25, v25 quad_perm:[2,3,0,1] row_mask:0xf bank_mask:0xf
v_add_f32_dpp v26, v26, v26 quad_perm:[2,3,0,1] row_mask:0xf bank_mask:0xf
v_add_f32_dpp v27, v27, v27 quad_perm:[2,3,0,1] row_mask:0xf bank_mask:0xf
v_cvt_pk_bf16_f32 v52, v24, v25
v_cvt_pk_bf16_f32 v53, v26, v27
v_lshlrev_b32 v48, 16, v52
v_and_b32 v49, s90, v52
v_lshlrev_b32 v50, 16, v53
v_and_b32 v51, s90, v53
v_mul_f32 v48, s89, v48
v_mul_f32 v49, s89, v49
v_mul_f32 v50, s89, v50
v_mul_f32 v51, s89, v51
v_cvt_pk_bf16_f32 v52, v48, v49
v_cvt_pk_bf16_f32 v53, v50, v51
v_lshlrev_b32 v54, 16, v52
v_and_b32 v55, s90, v52
v_lshlrev_b32 v56, 16, v53
v_and_b32 v57, s90, v53
v_max3_f32 v19, v54, v55, v56
v_max3_f32 v19, v19, v57, v14
v_mov_b32 v62, v19
s_nop 0
s_nop 0
v_permlane16_swap_b32 v19, v62
v_max_f32 v19, v19, v62
v_mov_b32 v62, v19
s_nop 0
s_nop 0
v_permlane32_swap_b32 v19, v62
v_max_f32 v14, v19, v62
v_mul_f32 v15, s88, v14
v_sub_f32 v18, v16, v15
v_fma_f32 v54, v54, s88, -v15
v_fma_f32 v55, v55, s88, -v15
v_fma_f32 v56, v56, s88, -v15
v_fma_f32 v57, v57, s88, -v15
v_exp_f32 v18, v18
v_exp_f32 v54, v54
v_exp_f32 v55, v55
v_exp_f32 v56, v56
v_exp_f32 v57, v57
v_mov_b32 v16, v15
v_cvt_pk_bf16_f32 v58, v54, v54
v_cvt_pk_bf16_f32 v59, v55, v55
v_cvt_pk_bf16_f32 v60, v56, v56
v_cvt_pk_bf16_f32 v61, v57, v57
v_add_f32 v19, v54, v55
v_add_f32 v62, v56, v57
v_mul_f32 v20, v20, v18
v_mul_f32 v21, v21, v18
v_mul_f32 v22, v22, v18
v_mul_f32 v23, v23, v18
v_add_f32 v19, v19, v62
v_and_b32 v32, v58, v2
v_and_b32 v33, v58, v3
v_and_b32 v34, v58, v4
v_and_b32 v35, v58, v5
v_and_b32 v36, v59, v2
v_and_b32 v37, v59, v3
v_and_b32 v38, v59, v4
v_and_b32 v39, v59, v5
v_and_b32 v40, v60, v2
v_and_b32 v41, v60, v3
v_and_b32 v42, v60, v4
v_and_b32 v43, v60, v5
v_and_b32 v44, v61, v2
v_and_b32 v45, v61, v3
v_and_b32 v46, v61, v4
v_and_b32 v47, v61, v5
v_fma_f32 v17, v17, v18, v19
s_waitcnt vmcnt(12)
v_mfma_f32_16x16x32_bf16 v[20:23], a[16:19], v[32:35], v[20:23]
v_mfma_f32_16x16x32_bf16 v[20:23], a[20:23], v[36:39], v[20:23]
v_mfma_f32_16x16x32_bf16 v[20:23], a[24:27], v[40:43], v[20:23]
v_mfma_f32_16x16x32_bf16 v[20:23], a[28:31], v[44:47], v[20:23]
s_cmp_lt_u32 s66, 6
s_cbranch_scc1 L_skipV_1
buffer_load_dwordx4 a[48:51], v1, s[36:39], s65 offen offset:0 nt
buffer_load_dwordx4 a[52:55], v1, s[36:39], s65 offen offset:1024 nt
buffer_load_dwordx4 a[56:59], v1, s[36:39], s65 offen offset:2048 nt
buffer_load_dwordx4 a[60:63], v1, s[36:39], s65 offen offset:3072 nt
L_skipV_1:
s_add_u32 s66, s66, 1
s_cmp_ge_u32 s72, s64
s_cbranch_scc1 L_loop_end
s_cmp_ge_u32 s65, s64
s_cbranch_scc1 L_notk_2
s_cmp_lt_u32 s66, 6
s_cbranch_scc1 L_notk_2
v_mov_b32 v62, 0
v_mov_b32 v63, 1
s_mov_b64 exec, 1
ds_add_rtn_u32 v63, v62, v63 offset:27648
s_mov_b64 exec, -1
L_notk_2:
s_waitcnt vmcnt(12)
v_dot2_f32_bf16 v24, v96, v6, 0
v_dot2_f32_bf16 v28, v96, v10, 0
v_dot2_f32_bf16 v25, v100, v6, 0
v_dot2_f32_bf16 v29, v100, v10, 0
v_dot2_f32_bf16 v26, v104, v6, 0
v_dot2_f32_bf16 v30, v104, v10, 0
v_dot2_f32_bf16 v27, v108, v6, 0
v_dot2_f32_bf16 v31, v108, v10, 0
v_dot2c_f32_bf16 v24, v97, v7
v_dot2c_f32_bf16 v28, v97, v11
v_dot2c_f32_bf16 v25, v101, v7
v_dot2c_f32_bf16 v29, v101, v11
v_dot2c_f32_bf16 v26, v105, v7
v_dot2c_f32_bf16 v30, v105, v11
v_dot2c_f32_bf16 v27, v109, v7
v_dot2c_f32_bf16 v31, v109, v11
v_dot2c_f32_bf16 v24, v98, v8
v_dot2c_f32_bf16 v28, v98, v12
v_dot2c_f32_bf16 v25, v102, v8
v_dot2c_f32_bf16 v29, v102, v12
v_dot2c_f32_bf16 v26, v106, v8
v_dot2c_f32_bf16 v30, v106, v12
v_dot2c_f32_bf16 v27, v110, v8
v_dot2c_f32_bf16 v31, v110, v12
v_dot2c_f32_bf16 v24, v99, v9
v_dot2c_f32_bf16 v28, v99, v13
v_dot2c_f32_bf16 v25, v103, v9
v_dot2c_f32_bf16 v29, v103, v13
v_dot2c_f32_bf16 v26, v107, v9
v_dot2c_f32_bf16 v30, v107, v13
v_dot2c_f32_bf16 v27, v111, v9
v_dot2c_f32_bf16 v31, v111, v13
s_cmp_lt_u32 s66, 6
s_cbranch_scc1 L_skipK_2
s_cmp_ge_u32 s65, s64
s_cbranch_scc1 L_back_2
s_waitcnt lgkmcnt(0)
v_readfirstlane_b32 s6, v63
s_nop 0
s_cmp_lt_u32 s6, s67
s_cbranch_scc0 L_dyn_2
s_lshl_b32 s65, s6, 12
s_add_u32 s65, s65, s61
L_back_2:
s_mov_b32 s74, s65
buffer_load_dwordx4 v[128:131], v1, s[32:35], s65 offen offset:0 nt
buffer_load_dwordx4 v[132:135], v1, s[32:35], s65 offen offset:1024 nt
buffer_load_dwordx4 v[136:139], v1, s[32:35], s65 offen offset:2048 nt
buffer_load_dwordx4 v[140:143], v1, s[32:35], s65 offen offset:3072 nt
L_skipK_2:
v_add_f32_dpp v24, v24, v24 row_ror:8 row_mask:0xf bank_mask:0x3
v_add_f32_dpp v25, v25, v25 row_ror:8 row_mask:0xf bank_mask:0x3
v_add_f32_dpp v26, v26, v26 row_ror:8 row_mask:0xf bank_mask:0x3
v_add_f32_dpp v27, v27, v27 row_ror:8 row_mask:0xf bank_mask:0x3
v_add_f32_dpp v24, v28, v28 row_ror:8 row_mask:0xf bank_mask:0xc
v_add_f32_dpp v25, v29, v29 row_ror:8 row_mask:0xf bank_mask:0xc
v_add_f32_dpp v26, v30, v30 row_ror:8 row_mask:0xf bank_mask:0xc
v_add_f32_dpp v27, v31, v31 row_ror:8 row_mask:0xf bank_mask:0xc
v_add_f32_dpp v24, v24, v24 row_half_mirror row_mask:0xf bank_mask:0xf
v_add_f32_dpp v25, v25, v25 row_half_mirror row_mask:0xf bank_mask:0xf
v_add_f32_dpp v26, v26, v26 row_half_mirror row_mask:0xf bank_mask:0xf
v_add_f32_dpp v27, v27, v27 row_half_mirror row_mask:0xf bank_mask:0xf
v_add_f32_dpp v24, v24, v24 quad_perm:[1,0,3,2] row_mask:0xf bank_mask:0xf
v_add_f32_dpp v25, v25, v25 quad_perm:[1,0,3,2] row_mask:0xf bank_mask:0xf
v_add_f32_dpp v26, v26, v26 quad_perm:[1,0,3,2] row_mask:0xf bank_mask:0xf
v_add_f32_dpp v27, v27, v27 quad_perm:[1,0,3,2] row_mask:0xf bank_mask:0xf
v_add_f32_dpp v24, v24, v24 quad_perm:[2,3,0,1] row_mask:0xf bank_mask:0xf
v_add_f32_dpp v25, v25, v25 quad_perm:[2,3,0,1] row_mask:0xf bank_mask:0xf
v_add_f32_dpp v26, v26, v26 quad_perm:[2,3,0,1] row_mask:0xf bank_mask:0xf
v_add_f32_dpp v27, v27, v27 quad_perm:[2,3,0,1] row_mask:0xf bank_mask:0xf
v_cvt_pk_bf16_f32 v52, v24, v25
v_cvt_pk_bf16_f32 v53, v26, v27
v_lshlrev_b32 v48, 16, v52
v_and_b32 v49, s90, v52
v_lshlrev_b32 v50, 16, v53
v_and_b32 v51, s90, v53
v_mul_f32 v48, s89, v48
v_mul_f32 v49, s89, v49
v_mul_f32 v50, s89, v50
v_mul_f32 v51, s89, v51
v_cvt_pk_bf16_f32 v52, v48, v49
v_cvt_pk_bf16_f32 v53, v50, v51
v_lshlrev_b32 v54, 16, v52
v_and_b32 v55, s90, v52
v_lshlrev_b32 v56, 16, v53
v_and_b32 v57, s90, v53
v_max3_f32 v19, v54, v55, v56
v_max3_f32 v19, v19, v57, v14
v_mov_b32 v62, v19
s_nop 0
s_nop 0
v_permlane16_swap_b32 v19, v62
v_max_f32 v19, v19, v62
v_mov_b32 v62, v19
s_nop 0
s_nop 0
v_permlane32_swap_b32 v19, v62
v_max_f32 v14, v19, v62
v_mul_f32 v15, s88, v14
v_sub_f32 v18, v16, v15
v_fma_f32 v54, v54, s88, -v15
v_fma_f32 v55, v55, s88, -v15
v_fma_f32 v56, v56, s88, -v15
v_fma_f32 v57, v57, s88, -v15
v_exp_f32 v18, v18
v_exp_f32 v54, v54
v_exp_f32 v55, v55
v_exp_f32 v56, v56
v_exp_f32 v57, v57
v_mov_b32 v16, v15
v_cvt_pk_bf16_f32 v58, v54, v54
v_cvt_pk_bf16_f32 v59, v55, v55
v_cvt_pk_bf16_f32 v60, v56, v56
v_cvt_pk_bf16_f32 v61, v57, v57
v_add_f32 v19, v54, v55
v_add_f32 v62, v56, v57
v_mul_f32 v20, v20, v18
v_mul_f32 v21, v21, v18
v_mul_f32 v22, v22, v18
v_mul_f32 v23, v23, v18
v_add_f32 v19, v19, v62
v_and_b32 v32, v58, v2
v_and_b32 v33, v58, v3
v_and_b32 v34, v58, v4
v_and_b32 v35, v58, v5
v_and_b32 v36, v59, v2
v_and_b32 v37, v59, v3
v_and_b32 v38, v59, v4
v_and_b32 v39, v59, v5
v_and_b32 v40, v60, v2
v_and_b32 v41, v60, v3
v_and_b32 v42, v60, v4
v_and_b32 v43, v60, v5
v_and_b32 v44, v61, v2
v_and_b32 v45, v61, v3
v_and_b32 v46, v61, v4
v_and_b32 v47, v61, v5
v_fma_f32 v17, v17, v18, v19
s_waitcnt vmcnt(12)
v_mfma_f32_16x16x32_bf16 v[20:23], a[32:35], v[32:35], v[20:23]
v_mfma_f32_16x16x32_bf16 v[20:23], a[36:39], v[36:39], v[20:23]
v_mfma_f32_16x16x32_bf16 v[20:23], a[40:43], v[40:43], v[20:23]
v_mfma_f32_16x16x32_bf16 v[20:23], a[44:47], v[44:47], v[20:23]
s_cmp_lt_u32 s66, 6
s_cbranch_scc1 L_skipV_2
buffer_load_dwordx4 a[64:67], v1, s[36:39], s65 offen offset:0 nt
buffer_load_dwordx4 a[68:71], v1, s[36:39], s65 offen offset:1024 nt
buffer_load_dwordx4 a[72:75], v1, s[36:39], s65 offen offset:2048 nt
buffer_load_dwordx4 a[76:79], v1, s[36:39], s65 offen offset:3072 nt
L_skipV_2:
s_add_u32 s66, s66, 1
s_cmp_ge_u32 s73, s64
s_cbranch_scc1 L_loop_end
s_cmp_ge_u32 s65, s64
s_cbranch_scc1 L_notk_3
s_cmp_lt_u32 s66, 6
s_cbranch_scc1 L_notk_3
v_mov_b32 v62, 0
v_mov_b32 v63, 1
s_mov_b64 exec, 1
ds_add_rtn_u32 v63, v62, v63 offset:27648
s_mov_b64 exec, -1
L_notk_3:
s_waitcnt vmcnt(12)
v_dot2_f32_bf16 v24, v112, v6, 0
v_dot2_f32_bf16 v28, v112, v10, 0
v_dot2_f32_bf16 v25, v116, v6, 0
v_dot2_f32_bf16 v29, v116, v10, 0
v_dot2_f32_bf16 v26, v120, v6, 0
v_dot2_f32_bf16 v30, v120, v10, 0
v_dot2_f32_bf16 v27, v124, v6, 0
v_dot2_f32_bf16 v31, v124, v10, 0
v_dot2c_f32_bf16 v24, v113, v7
v_dot2c_f32_bf16 v28, v113, v11
v_dot2c_f32_bf16 v25, v117, v7
v_dot2c_f32_bf16 v29, v117, v11
v_dot2c_f32_bf16 v26, v121, v7
v_dot2c_f32_bf16 v30, v121, v11
v_dot2c_f32_bf16 v27, v125, v7
v_dot2c_f32_bf16 v31, v125, v11
v_dot2c_f32_bf16 v24, v114, v8
v_dot2c_f32_bf16 v28, v114, v12
v_dot2c_f32_bf16 v25, v118, v8
v_dot2c_f32_bf16 v29, v118, v12
v_dot2c_f32_bf16 v26, v122, v8
v_dot2c_f32_bf16 v30, v122, v12
v_dot2c_f32_bf16 v27, v126, v8
v_dot2c_f32_bf16 v31, v126, v12
v_dot2c_f32_bf16 v24, v115, v9
v_dot2c_f32_bf16 v28, v115, v13
v_dot2c_f32_bf16 v25, v119, v9
v_dot2c_f32_bf16 v29, v119, v13
v_dot2c_f32_bf16 v26, v123, v9
v_dot2c_f32_bf16 v30, v123, v13
v_dot2c_f32_bf16 v27, v127, v9
v_dot2c_f32_bf16 v31, v127, v13
s_cmp_lt_u32 s66, 6
s_cbranch_scc1 L_skipK_3
s_cmp_ge_u32 s65, s64
s_cbranch_scc1 L_back_3
s_waitcnt lgkmcnt(0)
v_readfirstlane_b32 s6, v63
s_nop 0
s_cmp_lt_u32 s6, s67
s_cbranch_scc0 L_dyn_3
s_lshl_b32 s65, s6, 12
s_add_u32 s65, s65, s61
L_back_3:
s_mov_b32 s75, s65
buffer_load_dwordx4 v[144:147], v1, s[32:35], s65 offen offset:0 nt
buffer_load_dwordx4 v[148:151], v1, s[32:35], s65 offen offset:1024 nt
buffer_load_dwordx4 v[152:155], v1, s[32:35], s65 offen offset:2048 nt
buffer_load_dwordx4 v[156:159], v1, s[32:35], s65 offen offset:3072 nt
L_skipK_3:
v_add_f32_dpp v24, v24, v24 row_ror:8 row_mask:0xf bank_mask:0x3
v_add_f32_dpp v25, v25, v25 row_ror:8 row_mask:0xf bank_mask:0x3
v_add_f32_dpp v26, v26, v26 row_ror:8 row_mask:0xf bank_mask:0x3
v_add_f32_dpp v27, v27, v27 row_ror:8 row_mask:0xf bank_mask:0x3
v_add_f32_dpp v24, v28, v28 row_ror:8 row_mask:0xf bank_mask:0xc
v_add_f32_dpp v25, v29, v29 row_ror:8 row_mask:0xf bank_mask:0xc
v_add_f32_dpp v26, v30, v30 row_ror:8 row_mask:0xf bank_mask:0xc
v_add_f32_dpp v27, v31, v31 row_ror:8 row_mask:0xf bank_mask:0xc
v_add_f32_dpp v24, v24, v24 row_half_mirror row_mask:0xf bank_mask:0xf
v_add_f32_dpp v25, v25, v25 row_half_mirror row_mask:0xf bank_mask:0xf
v_add_f32_dpp v26, v26, v26 row_half_mirror row_mask:0xf bank_mask:0xf
v_add_f32_dpp v27, v27, v27 row_half_mirror row_mask:0xf bank_mask:0xf
v_add_f32_dpp v24, v24, v24 quad_perm:[1,0,3,2] row_mask:0xf bank_mask:0xf
v_add_f32_dpp v25, v25, v25 quad_perm:[1,0,3,2] row_mask:0xf bank_mask:0xf
v_add_f32_dpp v26, v26, v26 quad_perm:[1,0,3,2] row_mask:0xf bank_mask:0xf
v_add_f32_dpp v27, v27, v27 quad_perm:[1,0,3,2] row_mask:0xf bank_mask:0xf
v_add_f32_dpp v24, v24, v24 quad_perm:[2,3,0,1] row_mask:0xf bank_mask:0xf
v_add_f32_dpp v25, v25, v25 quad_perm:[2,3,0,1] row_mask:0xf bank_mask:0xf
v_add_f32_dpp v26, v26, v26 quad_perm:[2,3,0,1] row_mask:0xf bank_mask:0xf
v_add_f32_dpp v27, v27, v27 quad_perm:[2,3,0,1] row_mask:0xf bank_mask:0xf
v_cvt_pk_bf16_f32 v52, v24, v25
v_cvt_pk_bf16_f32 v53, v26, v27
v_lshlrev_b32 v48, 16, v52
v_and_b32 v49, s90, v52
v_lshlrev_b32 v50, 16, v53
v_and_b32 v51, s90, v53
v_mul_f32 v48, s89, v48
v_mul_f32 v49, s89, v49
v_mul_f32 v50, s89, v50
v_mul_f32 v51, s89, v51
v_cvt_pk_bf16_f32 v52, v48, v49
v_cvt_pk_bf16_f32 v53, v50, v51
v_lshlrev_b32 v54, 16, v52
v_and_b32 v55, s90, v52
v_lshlrev_b32 v56, 16, v53
v_and_b32 v57, s90, v53
v_max3_f32 v19, v54, v55, v56
v_max3_f32 v19, v19, v57, v14
v_mov_b32 v62, v19
s_nop 0
s_nop 0
v_permlane16_swap_b32 v19, v62
v_max_f32 v19, v19, v62
v_mov_b32 v62, v19
s_nop 0
s_nop 0
v_permlane32_swap_b32 v19, v62
v_max_f32 v14, v19, v62
v_mul_f32 v15, s88, v14
v_sub_f32 v18, v16, v15
v_fma_f32 v54, v54, s88, -v15
v_fma_f32 v55, v55, s88, -v15
v_fma_f32 v56, v56, s88, -v15
v_fma_f32 v57, v57, s88, -v15
v_exp_f32 v18, v18
v_exp_f32 v54, v54
v_exp_f32 v55, v55
v_exp_f32 v56, v56
v_exp_f32 v57, v57
v_mov_b32 v16, v15
v_cvt_pk_bf16_f32 v58, v54, v54
v_cvt_pk_bf16_f32 v59, v55, v55
v_cvt_pk_bf16_f32 v60, v56, v56
v_cvt_pk_bf16_f32 v61, v57, v57
v_add_f32 v19, v54, v55
v_add_f32 v62, v56, v57
v_mul_f32 v20, v20, v18
v_mul_f32 v21, v21, v18
v_mul_f32 v22, v22, v18
v_mul_f32 v23, v23, v18
v_add_f32 v19, v19, v62
v_and_b32 v32, v58, v2
v_and_b32 v33, v58, v3
v_and_b32 v34, v58, v4
v_and_b32 v35, v58, v5
v_and_b32 v36, v59, v2
v_and_b32 v37, v59, v3
v_and_b32 v38, v59, v4
v_and_b32 v39, v59, v5
v_and_b32 v40, v60, v2
v_and_b32 v41, v60, v3
v_and_b32 v42, v60, v4
v_and_b32 v43, v60, v5
v_and_b32 v44, v61, v2
v_and_b32 v45, v61, v3
v_and_b32 v46, v61, v4
v_and_b32 v47, v61, v5
v_fma_f32 v17, v17, v18, v19
s_waitcnt vmcnt(12)
v_mfma_f32_16x16x32_bf16 v[20:23], a[48:51], v[32:35], v[20:23]
v_mfma_f32_16x16x32_bf16 v[20:23], a[52:55], v[36:39], v[20:23]
v_mfma_f32_16x16x32_bf16 v[20:23], a[56:59], v[40:43], v[20:23]
v_mfma_f32_16x16x32_bf16 v[20:23], a[60:63], v[44:47], v[20:23]
s_cmp_lt_u32 s66, 6
s_cbranch_scc1 L_skipV_3
buffer_load_dwordx4 a[80:83], v1, s[36:39], s65 offen offset:0 nt
buffer_load_dwordx4 a[84:87], v1, s[36:39], s65 offen offset:1024 nt
buffer_load_dwordx4 a[88:91], v1, s[36:39], s65 offen offset:2048 nt
buffer_load_dwordx4 a[92:95], v1, s[36:39], s65 offen offset:3072 nt
L_skipV_3:
s_add_u32 s66, s66, 1
s_cmp_ge_u32 s74, s64
s_cbranch_scc1 L_loop_end
s_cmp_ge_u32 s65, s64
s_cbranch_scc1 L_notk_4
v_mov_b32 v62, 0
v_mov_b32 v63, 1
s_mov_b64 exec, 1
ds_add_rtn_u32 v63, v62, v63 offset:27648
s_mov_b64 exec, -1
L_notk_4:
s_waitcnt vmcnt(12)
v_dot2_f32_bf16 v24, v128, v6, 0
v_dot2_f32_bf16 v28, v128, v10, 0
v_dot2_f32_bf16 v25, v132, v6, 0
v_dot2_f32_bf16 v29, v132, v10, 0
v_dot2_f32_bf16 v26, v136, v6, 0
v_dot2_f32_bf16 v30, v136, v10, 0
v_dot2_f32_bf16 v27, v140, v6, 0
v_dot2_f32_bf16 v31, v140, v10, 0
v_dot2c_f32_bf16 v24, v129, v7
v_dot2c_f32_bf16 v28, v129, v11
v_dot2c_f32_bf16 v25, v133, v7
v_dot2c_f32_bf16 v29, v133, v11
v_dot2c_f32_bf16 v26, v137, v7
v_dot2c_f32_bf16 v30, v137, v11
v_dot2c_f32_bf16 v27, v141, v7
v_dot2c_f32_bf16 v31, v141, v11
v_dot2c_f32_bf16 v24, v130, v8
v_dot2c_f32_bf16 v28, v130, v12
v_dot2c_f32_bf16 v25, v134, v8
v_dot2c_f32_bf16 v29, v134, v12
v_dot2c_f32_bf16 v26, v138, v8
v_dot2c_f32_bf16 v30, v138, v12
v_dot2c_f32_bf16 v27, v142, v8
v_dot2c_f32_bf16 v31, v142, v12
v_dot2c_f32_bf16 v24, v131, v9
v_dot2c_f32_bf16 v28, v131, v13
v_dot2c_f32_bf16 v25, v135, v9
v_dot2c_f32_bf16 v29, v135, v13
v_dot2c_f32_bf16 v26, v139, v9
v_dot2c_f32_bf16 v30, v139, v13
v_dot2c_f32_bf16 v27, v143, v9
v_dot2c_f32_bf16 v31, v143, v13
s_cmp_ge_u32 s65, s64
s_cbranch_scc1 L_back_4
s_waitcnt lgkmcnt(0)
v_readfirstlane_b32 s6, v63
s_nop 0
s_cmp_lt_u32 s6, s67
s_cbranch_scc0 L_dyn_4
s_lshl_b32 s65, s6, 12
s_add_u32 s65, s65, s61
L_back_4:
s_mov_b32 s70, s65
buffer_load_dwordx4 v[64:67], v1, s[32:35], s65 offen offset:0 nt
buffer_load_dwordx4 v[68:71], v1, s[32:35], s65 offen offset:1024 nt
buffer_load_dwordx4 v[72:75], v1, s[32:35], s65 offen offset:2048 nt
buffer_load_dwordx4 v[76:79], v1, s[32:35], s65 offen offset:3072 nt
v_add_f32_dpp v24, v24, v24 row_ror:8 row_mask:0xf bank_mask:0x3
v_add_f32_dpp v25, v25, v25 row_ror:8 row_mask:0xf bank_mask:0x3
v_add_f32_dpp v26, v26, v26 row_ror:8 row_mask:0xf bank_mask:0x3
v_add_f32_dpp v27, v27, v27 row_ror:8 row_mask:0xf bank_mask:0x3
v_add_f32_dpp v24, v28, v28 row_ror:8 row_mask:0xf bank_mask:0xc
v_add_f32_dpp v25, v29, v29 row_ror:8 row_mask:0xf bank_mask:0xc
v_add_f32_dpp v26, v30, v30 row_ror:8 row_mask:0xf bank_mask:0xc
v_add_f32_dpp v27, v31, v31 row_ror:8 row_mask:0xf bank_mask:0xc
v_add_f32_dpp v24, v24, v24 row_half_mirror row_mask:0xf bank_mask:0xf
v_add_f32_dpp v25, v25, v25 row_half_mirror row_mask:0xf bank_mask:0xf
v_add_f32_dpp v26, v26, v26 row_half_mirror row_mask:0xf bank_mask:0xf
v_add_f32_dpp v27, v27, v27 row_half_mirror row_mask:0xf bank_mask:0xf
v_add_f32_dpp v24, v24, v24 quad_perm:[1,0,3,2] row_mask:0xf bank_mask:0xf
v_add_f32_dpp v25, v25, v25 quad_perm:[1,0,3,2] row_mask:0xf bank_mask:0xf
v_add_f32_dpp v26, v26, v26 quad_perm:[1,0,3,2] row_mask:0xf bank_mask:0xf
v_add_f32_dpp v27, v27, v27 quad_perm:[1,0,3,2] row_mask:0xf bank_mask:0xf
v_add_f32_dpp v24, v24, v24 quad_perm:[2,3,0,1] row_mask:0xf bank_mask:0xf
v_add_f32_dpp v25, v25, v25 quad_perm:[2,3,0,1] row_mask:0xf bank_mask:0xf
v_add_f32_dpp v26, v26, v26 quad_perm:[2,3,0,1] row_mask:0xf bank_mask:0xf
v_add_f32_dpp v27, v27, v27 quad_perm:[2,3,0,1] row_mask:0xf bank_mask:0xf
v_cvt_pk_bf16_f32 v52, v24, v25
v_cvt_pk_bf16_f32 v53, v26, v27
v_lshlrev_b32 v48, 16, v52
v_and_b32 v49, s90, v52
v_lshlrev_b32 v50, 16, v53
v_and_b32 v51, s90, v53
v_mul_f32 v48, s89, v48
v_mul_f32 v49, s89, v49
v_mul_f32 v50, s89, v50
v_mul_f32 v51, s89, v51
v_cvt_pk_bf16_f32 v52, v48, v49
v_cvt_pk_bf16_f32 v53, v50, v51
v_lshlrev_b32 v54, 16, v52
v_and_b32 v55, s90, v52
v_lshlrev_b32 v56, 16, v53
v_and_b32 v57, s90, v53
v_max3_f32 v19, v54, v55, v56
v_max3_f32 v19, v19, v57, v14
v_mov_b32 v62, v19
s_nop 0
s_nop 0
v_permlane16_swap_b32 v19, v62
v_max_f32 v19, v19, v62
v_mov_b32 v62, v19
s_nop 0
s_nop 0
v_permlane32_swap_b32 v19, v62
v_max_f32 v14, v19, v62
v_mul_f32 v15, s88, v14
v_sub_f32 v18, v16, v15
v_fma_f32 v54, v54, s88, -v15
v_fma_f32 v55, v55, s88, -v15
v_fma_f32 v56, v56, s88, -v15
v_fma_f32 v57, v57, s88, -v15
v_exp_f32 v18, v18
v_exp_f32 v54, v54
v_exp_f32 v55, v55
v_exp_f32 v56, v56
v_exp_f32 v57, v57
v_mov_b32 v16, v15
v_cvt_pk_bf16_f32 v58, v54, v54
v_cvt_pk_bf16_f32 v59, v55, v55
v_cvt_pk_bf16_f32 v60, v56, v56
v_cvt_pk_bf16_f32 v61, v57, v57
v_add_f32 v19, v54, v55
v_add_f32 v62, v56, v57
v_mul_f32 v20, v20, v18
v_mul_f32 v21, v21, v18
v_mul_f32 v22, v22, v18
v_mul_f32 v23, v23, v18
v_add_f32 v19, v19, v62
v_and_b32 v32, v58, v2
v_and_b32 v33, v58, v3
v_and_b32 v34, v58, v4
v_and_b32 v35, v58, v5
v_and_b32 v36, v59, v2
v_and_b32 v37, v59, v3
v_and_b32 v38, v59, v4
v_and_b32 v39, v59, v5
v_and_b32 v40, v60, v2
v_and_b32 v41, v60, v3
v_and_b32 v42, v60, v4
v_and_b32 v43, v60, v5
v_and_b32 v44, v61, v2
v_and_b32 v45, v61, v3
v_and_b32 v46, v61, v4
v_and_b32 v47, v61, v5
v_fma_f32 v17, v17, v18, v19
s_waitcnt vmcnt(12)
v_mfma_f32_16x16x32_bf16 v[20:23], a[64:67], v[32:35], v[20:23]
v_mfma_f32_16x16x32_bf16 v[20:23], a[68:71], v[36:39], v[20:23]
v_mfma_f32_16x16x32_bf16 v[20:23], a[72:75], v[40:43], v[20:23]
v_mfma_f32_16x16x32_bf16 v[20:23], a[76:79], v[44:47], v[20:23]
buffer_load_dwordx4 a[0:3], v1, s[36:39], s65 offen offset:0 nt
buffer_load_dwordx4 a[4:7], v1, s[36:39], s65 offen offset:1024 nt
buffer_load_dwordx4 a[8:11], v1, s[36:39], s65 offen offset:2048 nt
buffer_load_dwordx4 a[12:15], v1, s[36:39], s65 offen offset:3072 nt
s_add_u32 s66, s66, 1
s_cmp_ge_u32 s75, s64
s_cbranch_scc1 L_loop_end
s_cmp_ge_u32 s65, s64
s_cbranch_scc1 L_notk_5
v_mov_b32 v62, 0
v_mov_b32 v63, 1
s_mov_b64 exec, 1
ds_add_rtn_u32 v63, v62, v63 offset:27648
s_mov_b64 exec, -1
L_notk_5:
s_waitcnt vmcnt(12)
v_dot2_f32_bf16 v24, v144, v6, 0
v_dot2_f32_bf16 v28, v144, v10, 0
v_dot2_f32_bf16 v25, v148, v6, 0
v_dot2_f32_bf16 v29, v148, v10, 0
v_dot2_f32_bf16 v26, v152, v6, 0
v_dot2_f32_bf16 v30, v152, v10, 0
v_dot2_f32_bf16 v27, v156, v6, 0
v_dot2_f32_bf16 v31, v156, v10, 0
v_dot2c_f32_bf16 v24, v145, v7
v_dot2c_f32_bf16 v28, v145, v11
v_dot2c_f32_bf16 v25, v149, v7
v_dot2c_f32_bf16 v29, v149, v11
v_dot2c_f32_bf16 v26, v153, v7
v_dot2c_f32_bf16 v30, v153, v11
v_dot2c_f32_bf16 v27, v157, v7
v_dot2c_f32_bf16 v31, v157, v11
v_dot2c_f32_bf16 v24, v146, v8
v_dot2c_f32_bf16 v28, v146, v12
v_dot2c_f32_bf16 v25, v150, v8
v_dot2c_f32_bf16 v29, v150, v12
v_dot2c_f32_bf16 v26, v154, v8
v_dot2c_f32_bf16 v30, v154, v12
v_dot2c_f32_bf16 v27, v158, v8
v_dot2c_f32_bf16 v31, v158, v12
v_dot2c_f32_bf16 v24, v147, v9
v_dot2c_f32_bf16 v28, v147, v13
v_dot2c_f32_bf16 v25, v151, v9
v_dot2c_f32_bf16 v29, v151, v13
v_dot2c_f32_bf16 v26, v155, v9
v_dot2c_f32_bf16 v30, v155, v13
v_dot2c_f32_bf16 v27, v159, v9
v_dot2c_f32_bf16 v31, v159, v13
s_cmp_ge_u32 s65, s64
s_cbranch_scc1 L_back_5
s_waitcnt lgkmcnt(0)
v_readfirstlane_b32 s6, v63
s_nop 0
s_cmp_lt_u32 s6, s67
s_cbranch_scc0 L_dyn_5
s_lshl_b32 s65, s6, 12
s_add_u32 s65, s65, s61
L_back_5:
s_mov_b32 s71, s65
buffer_load_dwordx4 v[80:83], v1, s[32:35], s65 offen offset:0 nt
buffer_load_dwordx4 v[84:87], v1, s[32:35], s65 offen offset:1024 nt
buffer_load_dwordx4 v[88:91], v1, s[32:35], s65 offen offset:2048 nt
buffer_load_dwordx4 v[92:95], v1, s[32:35], s65 offen offset:3072 nt
v_add_f32_dpp v24, v24, v24 row_ror:8 row_mask:0xf bank_mask:0x3
v_add_f32_dpp v25, v25, v25 row_ror:8 row_mask:0xf bank_mask:0x3
v_add_f32_dpp v26, v26, v26 row_ror:8 row_mask:0xf bank_mask:0x3
v_add_f32_dpp v27, v27, v27 row_ror:8 row_mask:0xf bank_mask:0x3
v_add_f32_dpp v24, v28, v28 row_ror:8 row_mask:0xf bank_mask:0xc
v_add_f32_dpp v25, v29, v29 row_ror:8 row_mask:0xf bank_mask:0xc
v_add_f32_dpp v26, v30, v30 row_ror:8 row_mask:0xf bank_mask:0xc
v_add_f32_dpp v27, v31, v31 row_ror:8 row_mask:0xf bank_mask:0xc
v_add_f32_dpp v24, v24, v24 row_half_mirror row_mask:0xf bank_mask:0xf
v_add_f32_dpp v25, v25, v25 row_half_mirror row_mask:0xf bank_mask:0xf
v_add_f32_dpp v26, v26, v26 row_half_mirror row_mask:0xf bank_mask:0xf
v_add_f32_dpp v27, v27, v27 row_half_mirror row_mask:0xf bank_mask:0xf
v_add_f32_dpp v24, v24, v24 quad_perm:[1,0,3,2] row_mask:0xf bank_mask:0xf
v_add_f32_dpp v25, v25, v25 quad_perm:[1,0,3,2] row_mask:0xf bank_mask:0xf
v_add_f32_dpp v26, v26, v26 quad_perm:[1,0,3,2] row_mask:0xf bank_mask:0xf
v_add_f32_dpp v27, v27, v27 quad_perm:[1,0,3,2] row_mask:0xf bank_mask:0xf
v_add_f32_dpp v24, v24, v24 quad_perm:[2,3,0,1] row_mask:0xf bank_mask:0xf
v_add_f32_dpp v25, v25, v25 quad_perm:[2,3,0,1] row_mask:0xf bank_mask:0xf
v_add_f32_dpp v26, v26, v26 quad_perm:[2,3,0,1] row_mask:0xf bank_mask:0xf
v_add_f32_dpp v27, v27, v27 quad_perm:[2,3,0,1] row_mask:0xf bank_mask:0xf
v_cvt_pk_bf16_f32 v52, v24, v25
v_cvt_pk_bf16_f32 v53, v26, v27
v_lshlrev_b32 v48, 16, v52
v_and_b32 v49, s90, v52
v_lshlrev_b32 v50, 16, v53
v_and_b32 v51, s90, v53
v_mul_f32 v48, s89, v48
v_mul_f32 v49, s89, v49
v_mul_f32 v50, s89, v50
v_mul_f32 v51, s89, v51
v_cvt_pk_bf16_f32 v52, v48, v49
v_cvt_pk_bf16_f32 v53, v50, v51
v_lshlrev_b32 v54, 16, v52
v_and_b32 v55, s90, v52
v_lshlrev_b32 v56, 16, v53
v_and_b32 v57, s90, v53
v_max3_f32 v19, v54, v55, v56
v_max3_f32 v19, v19, v57, v14
v_mov_b32 v62, v19
s_nop 0
s_nop 0
v_permlane16_swap_b32 v19, v62
v_max_f32 v19, v19, v62
v_mov_b32 v62, v19
s_nop 0
s_nop 0
v_permlane32_swap_b32 v19, v62
v_max_f32 v14, v19, v62
v_mul_f32 v15, s88, v14
v_sub_f32 v18, v16, v15
v_fma_f32 v54, v54, s88, -v15
v_fma_f32 v55, v55, s88, -v15
v_fma_f32 v56, v56, s88, -v15
v_fma_f32 v57, v57, s88, -v15
v_exp_f32 v18, v18
v_exp_f32 v54, v54
v_exp_f32 v55, v55
v_exp_f32 v56, v56
v_exp_f32 v57, v57
v_mov_b32 v16, v15
v_cvt_pk_bf16_f32 v58, v54, v54
v_cvt_pk_bf16_f32 v59, v55, v55
v_cvt_pk_bf16_f32 v60, v56, v56
v_cvt_pk_bf16_f32 v61, v57, v57
v_add_f32 v19, v54, v55
v_add_f32 v62, v56, v57
v_mul_f32 v20, v20, v18
v_mul_f32 v21, v21, v18
v_mul_f32 v22, v22, v18
v_mul_f32 v23, v23, v18
v_add_f32 v19, v19, v62
v_and_b32 v32, v58, v2
v_and_b32 v33, v58, v3
v_and_b32 v34, v58, v4
v_and_b32 v35, v58, v5
v_and_b32 v36, v59, v2
v_and_b32 v37, v59, v3
v_and_b32 v38, v59, v4
v_and_b32 v39, v59, v5
v_and_b32 v40, v60, v2
v_and_b32 v41, v60, v3
v_and_b32 v42, v60, v4
v_and_b32 v43, v60, v5
v_and_b32 v44, v61, v2
v_and_b32 v45, v61, v3
v_and_b32 v46, v61, v4
v_and_b32 v47, v61, v5
v_fma_f32 v17, v17, v18, v19
s_waitcnt vmcnt(12)
v_mfma_f32_16x16x32_bf16 v[20:23], a[80:83], v[32:35], v[20:23]
v_mfma_f32_16x16x32_bf16 v[20:23], a[84:87], v[36:39], v[20:23]
v_mfma_f32_16x16x32_bf16 v[20:23], a[88:91], v[40:43], v[20:23]
v_mfma_f32_16x16x32_bf16 v[20:23], a[92:95], v[44:47], v[20:23]
buffer_load_dwordx4 a[16:19], v1, s[36:39], s65 offen offset:0 nt
buffer_load_dwordx4 a[20:23], v1, s[36:39], s65 offen offset:1024 nt
buffer_load_dwordx4 a[24:27], v1, s[36:39], s65 offen offset:2048 nt
buffer_load_dwordx4 a[28:31], v1, s[36:39], s65 offen offset:3072 nt
s_add_u32 s66, s66, 1
s_branch L_loop
L_dyn_0:
s_sub_u32 s7, s6, s67
s_and_b32 s7, s7, -4
v_mov_b32 v62, s7
s_and_b32 s6, s6, 3
s_lshl_b32 s59, s6, 12
s_mov_b32 s82, 0
L_dynsp_0:
ds_read_b32 v63, v62 offset:26624
s_waitcnt lgkmcnt(0)
v_readfirstlane_b32 s65, v63
s_nop 0
s_cmp_eq_u32 s65, -1
s_cbranch_scc1 L_dynw_0
s_add_u32 s65, s65, s59
s_branch L_back_0
L_dynw_0:
s_sleep 1
s_add_u32 s82, s82, 1
s_cmp_lt_u32 s82, 0x100000
s_cbranch_scc1 L_dynsp_0
s_branch L_exit
L_dyn_1:
s_sub_u32 s7, s6, s67
s_and_b32 s7, s7, -4
v_mov_b32 v62, s7
s_and_b32 s6, s6, 3
s_lshl_b32 s59, s6, 12
s_mov_b32 s82, 0
L_dynsp_1:
ds_read_b32 v63, v62 offset:26624
s_waitcnt lgkmcnt(0)
v_readfirstlane_b32 s65, v63
s_nop 0
s_cmp_eq_u32 s65, -1
s_cbranch_scc1 L_dynw_1
s_add_u32 s65, s65, s59
s_branch L_back_1
L_dynw_1:
s_sleep 1
s_add_u32 s82, s82, 1
s_cmp_lt_u32 s82, 0x100000
s_cbranch_scc1 L_dynsp_1
s_branch L_exit
L_dyn_2:
s_sub_u32 s7, s6, s67
s_and_b32 s7, s7, -4
v_mov_b32 v62, s7
s_and_b32 s6, s6, 3
s_lshl_b32 s59, s6, 12
s_mov_b32 s82, 0
L_dynsp_2:
ds_read_b32 v63, v62 offset:26624
s_waitcnt lgkmcnt(0)
v_readfirstlane_b32 s65, v63
s_nop 0
s_cmp_eq_u32 s65, -1
s_cbranch_scc1 L_dynw_2
s_add_u32 s65, s65, s59
s_branch L_back_2
L_dynw_2:
s_sleep 1
s_add_u32 s82, s82, 1
s_cmp_lt_u32 s82, 0x100000
s_cbranch_scc1 L_dynsp_2
s_branch L_exit
L_dyn_3:
s_sub_u32 s7, s6, s67
s_and_b32 s7, s7, -4
v_mov_b32 v62, s7
s_and_b32 s6, s6, 3
s_lshl_b32 s59, s6, 12
s_mov_b32 s82, 0
L_dynsp_3:
ds_read_b32 v63, v62 offset:26624
s_waitcnt lgkmcnt(0)
v_readfirstlane_b32 s65, v63
s_nop 0
s_cmp_eq_u32 s65, -1
s_cbranch_scc1 L_dynw_3
s_add_u32 s65, s65, s59
s_branch L_back_3
L_dynw_3:
s_sleep 1
s_add_u32 s82, s82, 1
s_cmp_lt_u32 s82, 0x100000
s_cbranch_scc1 L_dynsp_3
s_branch L_exit
L_dyn_4:
s_sub_u32 s7, s6, s67
s_and_b32 s7, s7, -4
v_mov_b32 v62, s7
s_and_b32 s6, s6, 3
s_lshl_b32 s59, s6, 12
s_mov_b32 s82, 0
L_dynsp_4:
ds_read_b32 v63, v62 offset:26624
s_waitcnt lgkmcnt(0)
v_readfirstlane_b32 s65, v63
s_nop 0
s_cmp_eq_u32 s65, -1
s_cbranch_scc1 L_dynw_4
s_add_u32 s65, s65, s59
s_branch L_back_4
L_dynw_4:
s_sleep 1
s_add_u32 s82, s82, 1
s_cmp_lt_u32 s82, 0x100000
s_cbranch_scc1 L_dynsp_4
s_branch L_exit
L_dyn_5:
s_sub_u32 s7, s6, s67
s_and_b32 s7, s7, -4
v_mov_b32 v62, s7
s_and_b32 s6, s6, 3
s_lshl_b32 s59, s6, 12
s_mov_b32 s82, 0
L_dynsp_5:
ds_read_b32 v63, v62 offset:26624
s_waitcnt lgkmcnt(0)
v_readfirstlane_b32 s65, v63
s_nop 0
s_cmp_eq_u32 s65, -1
s_cbranch_scc1 L_dynw_5
s_add_u32 s65, s65, s59
s_branch L_back_5
L_dynw_5:
s_sleep 1
s_add_u32 s82, s82, 1
s_cmp_lt_u32 s82, 0x100000
s_cbranch_scc1 L_dynsp_5
s_branch L_exit
L_loop_end:
v_mov_b32 v62, v17
s_nop 1
v_permlane16_swap_b32 v17, v62
v_add_f32 v17, v17, v62
v_mov_b32 v62, v17
s_nop 0
s_nop 0
v_permlane32_swap_b32 v17, v62
v_add_f32 v17, v17, v62
s_lshl_b32 s6, s58, 10
v_add_u32 v62, s6, v1
ds_write_b128 v62, v[20:23] offset:3072
v_bfe_u32 v63, v0, 3, 1
v_lshlrev_b32 v63, 3, v63
s_lshl_b32 s6, s58, 4
v_add_u32 v62, s6, v63
s_mov_b64 exec, 0x101
ds_write_b64 v62, v[16:17] offset:2880
s_mov_b64 exec, -1
s_waitcnt lgkmcnt(0)
s_barrier
s_cmp_eq_u32 s58, 0
s_cbranch_scc0 L_exit
v_mov_b32 v57, 0
ds_read_b32 v56, v57 offset:2836
ds_read_b128 v[32:35], v1 offset:3072
ds_read_b64 v[48:49], v63 offset:2880
ds_read_b128 v[36:39], v1 offset:4096
ds_read_b64 v[50:51], v63 offset:2896
ds_read_b128 v[40:43], v1 offset:5120
ds_read_b64 v[52:53], v63 offset:2912
ds_read_b128 v[44:47], v1 offset:6144
ds_read_b64 v[54:55], v63 offset:2928
s_waitcnt lgkmcnt(0)
v_max3_f32 v16, v48, v50, v52
v_max_f32 v16, v16, v54
v_sub_f32 v24, v48, v16
v_sub_f32 v25, v50, v16
v_sub_f32 v26, v52, v16
v_sub_f32 v27, v54, v16
v_exp_f32 v24, v24
v_exp_f32 v25, v25
v_exp_f32 v26, v26
v_exp_f32 v27, v27
v_mul_f32 v17, v24, v49
v_fmac_f32 v17, v25, v51
v_fmac_f32 v17, v26, v53
v_fmac_f32 v17, v27, v55
v_mul_f32 v20, v24, v32
v_fmac_f32 v20, v25, v36
v_fmac_f32 v20, v26, v40
v_fmac_f32 v20, v27, v44
v_mul_f32 v21, v24, v33
v_fmac_f32 v21, v25, v37
v_fmac_f32 v21, v26, v41
v_fmac_f32 v21, v27, v45
v_mul_f32 v22, v24, v34
v_fmac_f32 v22, v25, v38
v_fmac_f32 v22, v26, v42
v_fmac_f32 v22, v27, v46
v_mul_f32 v23, v24, v35
v_fmac_f32 v23, v25, v39
v_fmac_f32 v23, v26, v43
v_fmac_f32 v23, v27, v47
s_mul_i32 s6, s56, 1152
s_add_u32 s6, s6, 0x20000
buffer_store_dwordx4 v[20:23], v1, s[40:43], s6 offen sc1
s_mov_b64 exec, 0x101
buffer_store_dwordx2 v[16:17], v63, s[40:43], s6 offen offset:1024 sc1
s_mov_b64 exec, -1
v_readfirstlane_b32 s55, v56
s_nop 0
s_cmp_lt_u32 s55, 9
s_cbranch_scc0 L_exit
s_barrier
L_exit:
L_end:
s_endpgm
.section .rodata,"a"
.p2align 6
.amdhsa_kernel parallel_sum__gqa_block_cached__glu_gated_geglu__decode_kernel
  .amdhsa_next_free_vgpr 256
  .amdhsa_next_free_sgpr 102
  .amdhsa_accum_offset 160
  .amdhsa_group_segment_fixed_size 0
  .amdhsa_kernarg_size 96
  .amdhsa_user_sgpr_count 2
  .amdhsa_user_sgpr_kernarg_segment_ptr 1
  .amdhsa_system_sgpr_workgroup_id_x 1
  .amdhsa_float_denorm_mode_32 3
.end_amdhsa_kernel
```
